```python
import torch

def _softmax(x, axis=-1):
    return torch.softmax(x, dim=axis)

def _gelu(x):
    return torch.nn.functional.gelu(x, approximate='tanh')

def _silu(x):
    return torch.nn.functional.silu(x)

def _sigmoid(x):
    return torch.sigmoid(x)

def _layernorm(x, axis=-1, eps=1e-05):
    m = x.mean(dim=axis, keepdim=True)
    v = x.var(dim=axis, keepdim=True, unbiased=False)
    return (x - m) / torch.sqrt(v + eps)

def _scatter_add(tgt, idx, src, axis=0):
    return tgt.clone().index_add_(axis, idx, src)

def _segment_sum(src, seg, n):
    out = torch.zeros((n,) + src.shape[1:], dtype=src.dtype)
    return out.index_add_(0, seg, src)

def _pad(x, pw):
    flat = tuple((v for pair in reversed(pw) for v in pair))
    return torch.nn.functional.pad(x, flat)
kernel_name = 'gated_mix__spectral_fnet__mixer_gmlp__prompt'

def setup_inputs():

    _w = lambda a: (lambda t: t.to(torch.bfloat16) if t.is_floating_point() else t)(torch.as_tensor(a))

    def _A_setup():
        B, S, D = (1, 2048, 640)
        ns = torch.arange(S)[:, None] * torch.arange(S)[None, :]
        nd = torch.arange(D)[:, None] * torch.arange(D)[None, :]
        Ws_re = torch.cos(-2.0 * torch.pi * ns / S).to(float)
        Ws_im = torch.sin(-2.0 * torch.pi * ns / S).to(float)
        Wd_re = torch.cos(-2.0 * torch.pi * nd / D).to(float)
        Wd_im = torch.sin(-2.0 * torch.pi * nd / D).to(float)
        return {'x': _w((lambda *s: torch.randn(*s, dtype=torch.bfloat16) * 0.05)(B, S, D)), 'dft_seq_re': _w(Ws_re), 'dft_seq_im': _w(Ws_im), 'dft_hid_re': _w(Wd_re), 'dft_hid_im': _w(Wd_im)}
    _A_in = _A_setup()

    def _B_setup():
        B, S, D, F = (1, 2048, 640, 1536)
        Fh = F // 2
        return {'x': _w((lambda *s: torch.randn(*s, dtype=torch.bfloat16) * 0.05)(B, S, D)), 'w_in': _w((lambda *s: torch.randn(*s, dtype=torch.bfloat16) * 0.8)(D, 2 * Fh)), 'w_sp': _w(0.01 * (lambda *s: torch.randn(*s, dtype=torch.bfloat16) * 0.8)(S, S)), 'b_sp': _w(1.0 + 0.01 * (lambda *s: torch.randn(*s, dtype=torch.bfloat16) * 0.8)(S)), 'w_out': _w((lambda *s: torch.randn(*s, dtype=torch.bfloat16) * 0.8)(Fh, D))}
    _B_in = _B_setup()
    return {'A_x': _A_in['x'], 'A_dft_seq_re': _A_in['dft_seq_re'], 'A_dft_seq_im': _A_in['dft_seq_im'], 'A_dft_hid_re': _A_in['dft_hid_re'], 'A_dft_hid_im': _A_in['dft_hid_im'], 'B_x': _B_in['x'], 'B_w_in': _B_in['w_in'], 'B_w_sp': _B_in['w_sp'], 'B_b_sp': _B_in['b_sp'], 'B_w_out': _B_in['w_out'], 'gate_w': _w((lambda *s: torch.randn(*s, dtype=torch.bfloat16) * 0.05)(640) * 16.0)}

def reference(A_x, A_dft_seq_re, A_dft_seq_im, A_dft_hid_re, A_dft_hid_im, B_x, B_w_in, B_w_sp, B_b_sp, B_w_out, gate_w):

    def _A_ref(x, dft_seq_re, dft_seq_im, dft_hid_re, dft_hid_im):
        a = torch.einsum('bsd,ed->bse', x, dft_hid_re)
        b = torch.einsum('bsd,ed->bse', x, dft_hid_im)
        y = torch.einsum('ts,bse->bte', dft_seq_re, a) - torch.einsum('ts,bse->bte', dft_seq_im, b)
        return y

    def _B_ref(x, w_in, w_sp, b_sp, w_out):
        B, S, D = x.shape
        F = w_in.shape[-1]
        Fh = F // 2
        z = _gelu(torch.einsum('bsd,df->bsf', x, w_in))
        z1 = z[..., :Fh].clone()
        z2 = _layernorm(z[..., Fh:], axis=-1)
        g = torch.einsum('ts,bsf->btf', w_sp, z2) + b_sp[None, :, None]
        return torch.einsum('bsf,fd->bsd', z1 * g, w_out)
    x = A_x
    g = _sigmoid((x * gate_w).sum(-1, keepdims=True))
    a = _A_ref(x, A_dft_seq_re, A_dft_seq_im, A_dft_hid_re, A_dft_hid_im)
    b = _B_ref(x, B_w_in, B_w_sp, B_b_sp, B_w_out)
    return g * a + (1 - g) * b
```

```asm
; @launch grid=(256,1,1) block=(256,1,1) lds=163840
.amdgcn_target "amdgcn-amd-amdhsa--gfx950"
.text
.globl gated_mix__spectral_fnet__mixer_gmlp__prompt_kernel
.p2align 8
.type gated_mix__spectral_fnet__mixer_gmlp__prompt_kernel,@function
gated_mix__spectral_fnet__mixer_gmlp__prompt_kernel:
    s_cmp_ge_u32 s2, 256
    s_cbranch_scc1 L_end
    s_load_dwordx2 s[4:5], s[0:1], 0
    s_load_dwordx2 s[8:9], s[0:1], 48
    s_getpc_b64 s[40:41]
    v_lshlrev_b32 v170, 4, v0
    s_mov_b32 s42, L_end-gated_mix__spectral_fnet__mixer_gmlp__prompt_kernel-256
    s_mov_b32 s43, 0x20000
    s_lshr_b32 s68, s2, 3
    s_lshl_b32 s69, s68, 12
    buffer_load_dwordx4 v[192:195], v170, s[40:43], s69 offen
    v_lshrrev_b32 v168, 6, v0
    v_and_b32 v0, 63, v0
    v_readfirstlane_b32 s50, v168
    s_and_b32 s48, s2, 6
    s_lshl_b32 s48, s48, 2
    s_lshr_b32 s69, s68, 2
    s_add_u32 s48, s48, s69
    s_xor_b32 s88, s68, s69
    s_and_b32 s88, s88, 1
    v_lshrrev_b32 v3, 4, v0
    v_lshrrev_b32 v168, 3, v0
    v_mul_u32_u24 v168, 40960, v168
    s_lshl_b32 s69, s50, 9
    s_add_u32 s69, s69, s48
    s_mulk_i32 s69, 1280
    s_mul_i32 s70, s88, 640
    v_and_b32 v169, 7, v0
    v_xor_b32 v169, v169, v3
    v_lshl_add_u32 v171, v169, 4, v168
    s_add_u32 s86, s69, s70
    s_mul_i32 s55, s50, 20480
    v_xor_b32 v168, 64, v171
    v_add_u32 v172, 326656, v168
    s_mov_b32 s6, 2621440
    s_mov_b32 s7, 0x20000
    s_waitcnt lgkmcnt(0)
    s_add_u32 m0, s55, 0
    s_nop 0
    buffer_load_dwordx4 v171, s[4:7], s86 offen lds
    buffer_load_dwordx4 v172, s[4:7], s86 offen offset:1024 lds
    s_add_u32 m0, s55, 1920
    s_nop 0
    buffer_load_dwordx4 v171, s[4:7], s86 offen offset:128 lds
    buffer_load_dwordx4 v172, s[4:7], s86 offen offset:1152 lds
    s_add_u32 m0, s55, 3840
    s_nop 0
    buffer_load_dwordx4 v171, s[4:7], s86 offen offset:256 lds
    buffer_load_dwordx4 v172, s[4:7], s86 offen offset:1280 lds
    s_load_dwordx2 s[28:29], s[0:1], 104
    s_load_dwordx2 s[16:17], s[0:1], 72
    s_load_dwordx2 s[36:37], s[0:1], 80
    s_load_dwordx2 s[32:33], s[0:1], 64
    s_load_dwordx2 s[12:13], s[0:1], 56
    s_load_dwordx2 s[20:21], s[0:1], 24
    s_load_dwordx2 s[24:25], s[0:1], 88
    s_load_dwordx2 s[44:45], s[0:1], 32
    v_lshlrev_b32 v2, 4, v0
    s_mov_b32 s56, s69
    s_sub_u32 s87, s69, s70
    s_add_u32 s87, s87, 640
    s_and_b32 s49, s2, 1
    s_lshl_b32 s49, s49, 2
    s_and_b32 s69, s68, 3
    s_add_u32 s49, s49, s69
    s_mul_i32 s69, s49, 192
    s_mul_i32 s70, s88, 983040
    s_add_u32 s59, s69, s70
    s_add_u32 s58, s59, 1536
    s_sub_u32 s89, s69, s70
    s_mul_i32 s68, s50, 3072
    s_add_u32 s60, s68, 81920
    s_mov_b32 s10, 1966080
    s_mov_b32 s11, 0x20000
    s_mul_i32 s69, s50, 49152
    v_mul_u32_u24 v169, 5462, v0
    v_lshrrev_b32 v169, 16, v169
    v_mul_u32_u24 v170, 2880, v169
    v_lshl_add_u32 v170, v0, 4, v170
    v_lshlrev_b32 v169, 2, v169
    v_and_b32 v169, 32, v169
    v_xor_b32 v170, v170, v169
    v_add_u32 v4, s69, v170
    s_add_u32 m0, s60, 0
    s_add_u32 s73, s58, 0
    buffer_load_dwordx4 v4, s[8:11], s73 offen lds
    v_add_u32 v168, 64, v0
    v_mul_u32_u24 v169, 5462, v168
    v_lshrrev_b32 v169, 16, v169
    v_mul_u32_u24 v170, 2880, v169
    v_lshl_add_u32 v170, v168, 4, v170
    v_lshlrev_b32 v169, 2, v169
    v_and_b32 v169, 32, v169
    v_xor_b32 v170, v170, v169
    s_sub_u32 s69, s69, 1024
    v_add_u32 v5, s69, v170
    buffer_load_dwordx4 v5, s[8:11], s73 offen offset:1024 lds
    v_add_u32 v168, 128, v0
    v_mul_u32_u24 v169, 5462, v168
    v_lshrrev_b32 v169, 16, v169
    v_mul_u32_u24 v170, 2880, v169
    v_lshl_add_u32 v170, v168, 4, v170
    v_lshlrev_b32 v169, 2, v169
    v_and_b32 v169, 32, v169
    v_xor_b32 v170, v170, v169
    s_sub_u32 s69, s69, 1024
    v_add_u32 v6, s69, v170
    buffer_load_dwordx4 v6, s[8:11], s73 offen offset:2048 lds
    s_lshr_b32 s51, s50, 1
    s_and_b32 s52, s50, 1
    s_mov_b32 s30, 41943040
    s_mov_b32 s31, 0x20000
    s_mov_b32 s18, 983040
    s_mov_b32 s19, 0x20000
    s_mov_b32 s38, 1280
    s_mov_b32 s39, 0x20000
    s_mov_b32 s34, 4096
    s_mov_b32 s35, 0x20000
    s_mov_b32 s14, 8388608
    s_mov_b32 s15, 0x20000
    s_mov_b32 s22, 819200
    s_mov_b32 s23, 0x20000
    s_mov_b32 s26, 2621440
    s_mov_b32 s27, 0x20000
    s_waitcnt lgkmcnt(0)
    s_load_dword s54, s[28:29], 0
    s_cmp_lg_u32 s51, 0
    s_cselect_b32 s20, s44, s20
    s_cselect_b32 s21, s45, s21
    s_lshl_b32 s70, s2, 2
    s_add_u32 s70, s70, s50
    s_and_b32 s70, s70, 511
    s_lshl_b32 s70, s70, 7
    s_mov_b64 exec, 1
    buffer_load_dword v196, v2, s[28:31], s70 offen
    s_mov_b64 exec, -1
    s_lshl_b32 s70, s2, 1
    s_add_u32 s70, s70, s52
    s_lshl_b32 s70, s70, 4
    v_add_u32 v200, s70, v0
    v_mul_u32_u24 v201, 2731, v200
    v_lshrrev_b32 v201, 16, v201
    v_mul_u32_u24 v201, 896, v201
    v_lshl_add_u32 v200, v200, 4, v201
    s_mov_b64 exec, 0xffff
    buffer_load_dwordx4 v[200:203], v200, s[20:23], 0 offen
    s_mov_b64 exec, -1
    s_add_u32 m0, s60, 12288
    s_add_u32 s73, s58, 196608
    buffer_load_dwordx4 v4, s[8:11], s73 offen lds
    buffer_load_dwordx4 v5, s[8:11], s73 offen offset:1024 lds
    buffer_load_dwordx4 v6, s[8:11], s73 offen offset:2048 lds
    v_lshrrev_b32 v7, 5, v0
    v_and_b32 v8, 15, v0
    v_lshrrev_b32 v168, 1, v8
    v_xor_b32 v168, v168, v3
    v_lshlrev_b32 v174, 4, v168
    v_lshl_add_u32 v168, v8, 7, v174
    v_add_u32 v170, s55, v168
    v_xor_b32 v173, 64, v170
    v_bfe_u32 v168, v0, 2, 2
    v_lshl_add_u32 v168, v3, 3, v168
    v_mul_u32_u24 v168, 192, v168
    v_and_b32 v169, 3, v0
    v_lshl_add_u32 v168, v169, 3, v168
    v_add_u32 v168, 81920, v168
    v_and_b32 v169, 16, v0
    v_lshlrev_b32 v169, 1, v169
    v_add_u32 v9, v168, v169
    v_sub_u32 v10, v168, v169
    s_add_u32 m0, s60, 24576
    s_add_u32 s73, s58, 393216
    buffer_load_dwordx4 v4, s[8:11], s73 offen lds
    buffer_load_dwordx4 v5, s[8:11], s73 offen offset:1024 lds
    buffer_load_dwordx4 v6, s[8:11], s73 offen offset:2048 lds
    s_waitcnt lgkmcnt(0)
    v_mov_b32 v13, 0
    v_lshlrev_b32 v15, 2, v0
    v_lshrrev_b32 v178, 3, v0
    v_lshlrev_b32 v178, 17, v178
    v_and_b32 v179, 7, v0
    v_xor_b32 v179, v179, v3
    v_lshl_add_u32 v16, v179, 4, v178
    v_xor_b32 v178, 64, v16
    v_add_u32 v17, 1047552, v178
    s_and_b32 s46, s49, 5
    s_lshl_b32 s70, s46, 7
    s_lshl_b32 s68, s48, 12
    s_lshl_b32 s69, s50, 10
    s_add_u32 s68, s68, s69
    s_add_u32 s68, s68, s70
    s_xor_b32 s69, s50, 0
    s_lshl_b32 s69, s69, 21
    s_add_u32 s61, s68, s69
    s_xor_b32 s69, s50, 1
    s_lshl_b32 s69, s69, 21
    s_add_u32 s62, s68, s69
    s_xor_b32 s69, s50, 2
    s_lshl_b32 s69, s69, 21
    s_add_u32 s63, s68, s69
    s_xor_b32 s69, s50, 3
    s_lshl_b32 s69, s69, 21
    s_add_u32 s64, s68, s69
    v_mul_u32_u24 v178, 96, v7
    v_xor_b32 v18, v178, v170
    v_xor_b32 v19, 32, v18
    v_add_u32 v11, 49152, v9
    v_add_u32 v12, 49152, v10
    v_mov_b32 v20, 0xc0135761
    v_mov_b32 v21, 0xbdd2d3e8
    v_lshlrev_b32 v178, 6, v8
    s_lshl_b32 s68, s50, 10
    s_lshl_b32 s69, s48, 1
    s_add_u32 s68, s68, s69
    buffer_load_ushort v22, v178, s[32:35], s68 offen
    s_lshl_b32 s68, s48, 2
    s_add_u32 s68, s68, s50
    s_lshl_b32 s69, s68, 11
    s_add_u32 s82, s69, 65536
    s_mul_i32 s68, s68, 24576
    s_add_u32 s67, s68, 4194304
    s_lshl_b32 s68, s49, 10
    s_add_u32 s85, s67, s68
    s_and_b32 s68, s48, 3
    v_and_b32 v179, 3, v0
    v_xor_b32 v179, s68, v179
    s_waitcnt vmcnt(9)
    s_barrier
    ds_read_b128 v[64:67], v170 offset:0
    ds_read_b64_tr_b16 a[200:201], v9 offset:0
    ds_read_b64_tr_b16 a[202:203], v9 offset:768
    ds_read_b64_tr_b16 a[232:233], v10 offset:32
    ds_read_b64_tr_b16 a[234:235], v10 offset:800
    ds_read_b64_tr_b16 a[204:205], v9 offset:64
    ds_read_b64_tr_b16 a[206:207], v9 offset:832
    ds_read_b64_tr_b16 a[236:237], v10 offset:96
    ds_read_b64_tr_b16 a[238:239], v10 offset:864
    ds_read_b64_tr_b16 a[208:209], v9 offset:128
    ds_read_b64_tr_b16 a[210:211], v9 offset:896
    ds_read_b64_tr_b16 a[240:241], v10 offset:160
    s_add_u32 m0, s55, 5760
    ds_read_b64_tr_b16 a[242:243], v10 offset:928
    buffer_load_dwordx4 v171, s[4:7], s86 offen offset:384 lds
    buffer_load_dwordx4 v172, s[4:7], s86 offen offset:1408 lds
    s_add_u32 m0, s60, 36864
    s_add_u32 s73, s58, 589824
    buffer_load_dwordx4 v4, s[8:11], s73 offen lds
    s_waitcnt lgkmcnt(0)
    v_mfma_f32_16x16x32_bf16 v[144:147], a[200:203], v[64:67], 0
    ds_read_b128 v[68:71], v173 offset:0
    ds_read_b64_tr_b16 a[212:213], v9 offset:6144
    ds_read_b64_tr_b16 a[214:215], v9 offset:6912
    v_mfma_f32_16x16x32_bf16 v[148:151], a[232:235], v[64:67], 0
    ds_read_b64_tr_b16 a[244:245], v10 offset:6176
    ds_read_b64_tr_b16 a[246:247], v10 offset:6944
    ds_read_b64_tr_b16 a[216:217], v9 offset:6208
    v_mfma_f32_16x16x32_bf16 v[152:155], a[204:207], v[64:67], 0
    ds_read_b64_tr_b16 a[218:219], v9 offset:6976
    ds_read_b64_tr_b16 a[248:249], v10 offset:6240
    ds_read_b64_tr_b16 a[250:251], v10 offset:7008
    v_mfma_f32_16x16x32_bf16 v[156:159], a[236:239], v[64:67], 0
    ds_read_b64_tr_b16 a[220:221], v9 offset:6272
    ds_read_b64_tr_b16 a[222:223], v9 offset:7040
    ds_read_b64_tr_b16 a[252:253], v10 offset:6304
    buffer_load_dwordx4 v5, s[8:11], s73 offen offset:1024 lds
    v_mfma_f32_16x16x32_bf16 v[160:163], a[208:211], v[64:67], 0
    ds_read_b64_tr_b16 a[254:255], v10 offset:7072
    buffer_load_dwordx4 v6, s[8:11], s73 offen offset:2048 lds
    v_mfma_f32_16x16x32_bf16 v[164:167], a[240:243], v[64:67], 0
    s_and_b32 s68, s48, 7
    s_mul_i32 s68, s68, 96
    s_lshr_b32 s69, s48, 3
    s_lshl_b32 s69, s69, 5
    s_add_u32 s68, s68, s69
    s_lshl_b32 s69, s50, 3
    s_add_u32 s68, s68, s69
    s_mul_i32 s68, s68, 1280
    s_mul_i32 s69, s49, 160
    s_add_u32 s77, s68, s69
    s_mul_i32 s83, s50, 1280
    v_add_u32 v168, 0, v0
    v_mul_u32_u24 v169, 6554, v168
    v_lshrrev_b32 v169, 16, v169
    v_mul_u32_u24 v175, 10, v169
    v_sub_u32 v168, v168, v175
    v_mul_u32_u24 v169, 1280, v169
    s_add_u32 m0, s83, 131072
    v_lshl_add_u32 v168, v168, 4, v169
    buffer_load_dwordx4 v168, s[16:19], s77 offen lds
    v_add_u32 v168, 64, v0
    v_mul_u32_u24 v169, 6554, v168
    v_lshrrev_b32 v169, 16, v169
    v_mul_u32_u24 v175, 10, v169
    v_sub_u32 v168, v168, v175
    v_mul_u32_u24 v169, 1280, v169
    v_lshl_add_u32 v168, v168, 4, v169
    s_mov_b64 exec, 0xffff
    s_add_u32 m0, s83, 132096
    s_nop 0
    buffer_load_dwordx4 v168, s[16:19], s77 offen lds
    s_mov_b64 exec, -1
    s_add_u32 s68, s54, 1
    s_mul_i32 s68, s68, 0x9E3779B1
    s_xor_b32 s53, s68, 0x5bd1e995
    v_mov_b32 v14, s53
    v_bfe_u32 v178, v0, 2, 2
    v_lshlrev_b32 v178, 13, v178
    v_lshl_add_u32 v178, v179, 6, v178
    v_lshl_add_u32 v24, v3, 4, v178
    s_mul_i32 s68, s49, 12
    s_add_u32 s68, s68, s50
    s_lshl_b32 s68, s68, 15
    s_add_u32 s65, s68, 1048576
    s_lshl_b32 s69, s48, 8
    s_add_u32 s66, s65, s69
    v_mul_u32_u24 v178, 384, v8
    v_add_u32 v178, v178, v174
    v_add_u32 v25, 131072, v178
    v_xor_b32 v28, 64, v25
    v_and_b32 v179, 1, v0
    v_lshlrev_b32 v179, 14, v179
    v_xor_b32 v178, 16384, v179
    v_add_u32 v26, v25, v179
    v_add_u32 v27, v25, v178
    v_add_u32 v29, v28, v179
    v_add_u32 v30, v28, v178
    v_lshlrev_b32 v178, 30, v0
    v_and_b32 v178, 0x80000000, v178
    v_or_b32 v32, 1.0, v178
    v_lshlrev_b32 v179, 31, v0
    v_or_b32 v34, 1.0, v179
    v_xor_b32 v33, v32, v179
    v_mul_u32_u24 v178, 160, v8
    v_lshl_add_u32 v178, v3, 3, v178
    s_lshl_b32 s68, s50, 5
    s_add_u32 s68, s68, 106496
    v_add_u32 v31, s68, v178
    v_lshlrev_b32 v178, 4, v3
    v_add_u32 v36, 129536, v178
    s_mul_i32 s68, s88, 640
    v_subrev_u32 v37, s68, v36
    v_add_u32 v36, s68, v36
    s_sub_u32 s68, 0, s88
    v_and_b32 v179, s68, v179
    v_xor_b32 v38, v32, v179
    v_xor_b32 v39, v33, v179
    s_lshl_b32 s68, s50, 3
    v_and_b32 v178, 8, v0
    v_mul_u32_u24 v178, 3, v178
    v_add3_u32 v178, v178, v8, s68
    v_cvt_f32_u32 v178, v178
    v_mul_f32 v178, 0x3c800000, v178
    v_cvt_f32_u32 v180, v3
    v_mul_f32 v180, 0x41000000, v180
    v_mul_f32 v180, v180, v178
    s_waitcnt vmcnt(11) lgkmcnt(0)
    s_barrier
    v_mfma_f32_16x16x32_bf16 v[144:147], a[212:215], v[68:71], v[144:147]
    ds_read_b128 v[72:75], v170 offset:2048
    ds_read_b64_tr_b16 a[200:201], v9 offset:12288
    ds_read_b64_tr_b16 a[202:203], v9 offset:13056
    v_mfma_f32_16x16x32_bf16 v[148:151], a[244:247], v[68:71], v[148:151]
    ds_read_b64_tr_b16 a[232:233], v10 offset:12320
    ds_read_b64_tr_b16 a[234:235], v10 offset:13088
    ds_read_b64_tr_b16 a[204:205], v9 offset:12352
    v_mfma_f32_16x16x32_bf16 v[152:155], a[216:219], v[68:71], v[152:155]
    ds_read_b64_tr_b16 a[206:207], v9 offset:13120
    ds_read_b64_tr_b16 a[236:237], v10 offset:12384
    ds_read_b64_tr_b16 a[238:239], v10 offset:13152
    v_mfma_f32_16x16x32_bf16 v[156:159], a[248:251], v[68:71], v[156:159]
    ds_read_b64_tr_b16 a[208:209], v9 offset:12416
    ds_read_b64_tr_b16 a[210:211], v9 offset:13184
    s_add_u32 m0, s55, 7680
    ds_read_b64_tr_b16 a[240:241], v10 offset:12448
    buffer_load_dwordx4 v171, s[4:7], s86 offen offset:512 lds
    v_mfma_f32_16x16x32_bf16 v[160:163], a[220:223], v[68:71], v[160:163]
    ds_read_b64_tr_b16 a[242:243], v10 offset:13216
    buffer_load_dwordx4 v172, s[4:7], s86 offen offset:1536 lds
    v_mfma_f32_16x16x32_bf16 v[164:167], a[252:255], v[68:71], v[164:167]
    s_add_u32 m0, s60, 0
    s_add_u32 s73, s58, 786432
    buffer_load_dwordx4 v4, s[8:11], s73 offen lds
    s_waitcnt lgkmcnt(0)
    v_mfma_f32_16x16x32_bf16 v[144:147], a[200:203], v[72:75], v[144:147]
    ds_read_b128 v[76:79], v173 offset:2048
    ds_read_b64_tr_b16 a[212:213], v9 offset:18432
    ds_read_b64_tr_b16 a[214:215], v9 offset:19200
    v_mfma_f32_16x16x32_bf16 v[148:151], a[232:235], v[72:75], v[148:151]
    ds_read_b64_tr_b16 a[244:245], v10 offset:18464
    ds_read_b64_tr_b16 a[246:247], v10 offset:19232
    ds_read_b64_tr_b16 a[216:217], v9 offset:18496
    v_mfma_f32_16x16x32_bf16 v[152:155], a[204:207], v[72:75], v[152:155]
    ds_read_b64_tr_b16 a[218:219], v9 offset:19264
    ds_read_b64_tr_b16 a[248:249], v10 offset:18528
    ds_read_b64_tr_b16 a[250:251], v10 offset:19296
    v_mfma_f32_16x16x32_bf16 v[156:159], a[236:239], v[72:75], v[156:159]
    ds_read_b64_tr_b16 a[220:221], v9 offset:18560
    ds_read_b64_tr_b16 a[222:223], v9 offset:19328
    ds_read_b64_tr_b16 a[252:253], v10 offset:18592
    buffer_load_dwordx4 v5, s[8:11], s73 offen offset:1024 lds
    v_mfma_f32_16x16x32_bf16 v[160:163], a[208:211], v[72:75], v[160:163]
    ds_read_b64_tr_b16 a[254:255], v10 offset:19360
    buffer_load_dwordx4 v6, s[8:11], s73 offen offset:2048 lds
    v_mfma_f32_16x16x32_bf16 v[164:167], a[240:243], v[72:75], v[164:167]
    v_mul_f32 v179, 0x41c80000, v178
    v_add_f32 v181, v180, v178
    v_cos_f32 v182, v180
    v_cos_f32 v183, v181
    v_sin_f32_e64 v184, -v180
    v_sin_f32_e64 v185, -v181
    v_cvt_pk_bf16_f32 v182, v182, v183
    v_cvt_pk_bf16_f32 v184, v184, v185
    v_accvgpr_write_b32 a192, v182
    v_accvgpr_write_b32 a196, v184
    v_add_f32 v180, v181, v178
    v_add_f32 v181, v180, v178
    v_cos_f32 v182, v180
    v_cos_f32 v183, v181
    v_sin_f32_e64 v184, -v180
    v_sin_f32_e64 v185, -v181
    v_cvt_pk_bf16_f32 v182, v182, v183
    v_cvt_pk_bf16_f32 v184, v184, v185
    v_accvgpr_write_b32 a193, v182
    v_accvgpr_write_b32 a197, v184
    v_add_f32 v180, v181, v178
    v_add_f32 v181, v180, v178
    v_cos_f32 v182, v180
    v_cos_f32 v183, v181
    v_sin_f32_e64 v184, -v180
    v_sin_f32_e64 v185, -v181
    v_cvt_pk_bf16_f32 v182, v182, v183
    v_cvt_pk_bf16_f32 v184, v184, v185
    v_accvgpr_write_b32 a194, v182
    v_accvgpr_write_b32 a198, v184
    v_add_f32 v180, v181, v178
    v_add_f32 v181, v180, v178
    v_cos_f32 v182, v180
    v_cos_f32 v183, v181
    v_sin_f32_e64 v184, -v180
    v_sin_f32_e64 v185, -v181
    v_cvt_pk_bf16_f32 v182, v182, v183
    v_cvt_pk_bf16_f32 v184, v184, v185
    v_accvgpr_write_b32 a195, v182
    v_accvgpr_write_b32 a199, v184
    v_add_f32 v180, v181, v179
    s_waitcnt vmcnt(13) lgkmcnt(0)
    s_barrier
    v_mfma_f32_16x16x32_bf16 v[144:147], a[212:215], v[76:79], v[144:147]
    ds_read_b128 v[80:83], v170 offset:4096
    ds_read_b64_tr_b16 a[200:201], v9 offset:24576
    ds_read_b64_tr_b16 a[202:203], v9 offset:25344
    v_mfma_f32_16x16x32_bf16 v[148:151], a[244:247], v[76:79], v[148:151]
    ds_read_b64_tr_b16 a[232:233], v10 offset:24608
    ds_read_b64_tr_b16 a[234:235], v10 offset:25376
    ds_read_b64_tr_b16 a[204:205], v9 offset:24640
    v_mfma_f32_16x16x32_bf16 v[152:155], a[216:219], v[76:79], v[152:155]
    ds_read_b64_tr_b16 a[206:207], v9 offset:25408
    ds_read_b64_tr_b16 a[236:237], v10 offset:24672
    ds_read_b64_tr_b16 a[238:239], v10 offset:25440
    v_mfma_f32_16x16x32_bf16 v[156:159], a[248:251], v[76:79], v[156:159]
    ds_read_b64_tr_b16 a[208:209], v9 offset:24704
    ds_read_b64_tr_b16 a[210:211], v9 offset:25472
    s_add_u32 m0, s55, 10240
    ds_read_b64_tr_b16 a[240:241], v10 offset:24736
    buffer_load_dwordx4 v171, s[4:7], s87 offen lds
    v_mfma_f32_16x16x32_bf16 v[160:163], a[220:223], v[76:79], v[160:163]
    ds_read_b64_tr_b16 a[242:243], v10 offset:25504
    buffer_load_dwordx4 v172, s[4:7], s87 offen offset:1024 lds
    v_mfma_f32_16x16x32_bf16 v[164:167], a[252:255], v[76:79], v[164:167]
    s_add_u32 m0, s60, 12288
    s_add_u32 s73, s89, 984576
    buffer_load_dwordx4 v4, s[8:11], s73 offen lds
    s_waitcnt lgkmcnt(0)
    v_mfma_f32_16x16x32_bf16 v[144:147], a[200:203], v[80:83], v[144:147]
    ds_read_b128 v[84:87], v173 offset:4096
    ds_read_b64_tr_b16 a[212:213], v9 offset:30720
    ds_read_b64_tr_b16 a[214:215], v9 offset:31488
    v_mfma_f32_16x16x32_bf16 v[148:151], a[232:235], v[80:83], v[148:151]
    ds_read_b64_tr_b16 a[244:245], v10 offset:30752
    ds_read_b64_tr_b16 a[246:247], v10 offset:31520
    ds_read_b64_tr_b16 a[216:217], v9 offset:30784
    v_mfma_f32_16x16x32_bf16 v[152:155], a[204:207], v[80:83], v[152:155]
    ds_read_b64_tr_b16 a[218:219], v9 offset:31552
    ds_read_b64_tr_b16 a[248:249], v10 offset:30816
    ds_read_b64_tr_b16 a[250:251], v10 offset:31584
    v_mfma_f32_16x16x32_bf16 v[156:159], a[236:239], v[80:83], v[156:159]
    ds_read_b64_tr_b16 a[220:221], v9 offset:30848
    ds_read_b64_tr_b16 a[222:223], v9 offset:31616
    ds_read_b64_tr_b16 a[252:253], v10 offset:30880
    buffer_load_dwordx4 v5, s[8:11], s73 offen offset:1024 lds
    v_mfma_f32_16x16x32_bf16 v[160:163], a[208:211], v[80:83], v[160:163]
    ds_read_b64_tr_b16 a[254:255], v10 offset:31648
    buffer_load_dwordx4 v6, s[8:11], s73 offen offset:2048 lds
    v_mfma_f32_16x16x32_bf16 v[164:167], a[240:243], v[80:83], v[164:167]
    v_add_f32 v181, v180, v178
    v_cos_f32 v182, v180
    v_cos_f32 v183, v181
    v_sin_f32_e64 v184, -v180
    v_sin_f32_e64 v185, -v181
    v_cvt_pk_bf16_f32 v182, v182, v183
    v_cvt_pk_bf16_f32 v184, v184, v185
    v_accvgpr_write_b32 a224, v182
    v_accvgpr_write_b32 a228, v184
    v_add_f32 v180, v181, v178
    v_add_f32 v181, v180, v178
    v_cos_f32 v182, v180
    v_cos_f32 v183, v181
    v_sin_f32_e64 v184, -v180
    v_sin_f32_e64 v185, -v181
    v_cvt_pk_bf16_f32 v182, v182, v183
    v_cvt_pk_bf16_f32 v184, v184, v185
    v_accvgpr_write_b32 a225, v182
    v_accvgpr_write_b32 a229, v184
    v_add_f32 v180, v181, v178
    v_add_f32 v181, v180, v178
    v_cos_f32 v182, v180
    v_cos_f32 v183, v181
    v_sin_f32_e64 v184, -v180
    v_sin_f32_e64 v185, -v181
    v_cvt_pk_bf16_f32 v182, v182, v183
    v_cvt_pk_bf16_f32 v184, v184, v185
    v_accvgpr_write_b32 a226, v182
    v_accvgpr_write_b32 a230, v184
    v_add_f32 v180, v181, v178
    v_add_f32 v181, v180, v178
    v_cos_f32 v182, v180
    v_cos_f32 v183, v181
    v_sin_f32_e64 v184, -v180
    v_sin_f32_e64 v185, -v181
    v_cvt_pk_bf16_f32 v182, v182, v183
    v_cvt_pk_bf16_f32 v184, v184, v185
    v_accvgpr_write_b32 a227, v182
    v_accvgpr_write_b32 a231, v184
    s_lshl_b32 s68, s52, 9
    v_add_u32 v181, s68, v0
    s_lshl_b32 s84, s50, 13
    s_mul_i32 s76, s49, 51200
    s_waitcnt vmcnt(12) lgkmcnt(0)
    s_barrier
    v_mfma_f32_16x16x32_bf16 v[144:147], a[212:215], v[84:87], v[144:147]
    ds_read_b128 v[88:91], v170 offset:6144
    ds_read_b64_tr_b16 a[200:201], v9 offset:36864
    ds_read_b64_tr_b16 a[202:203], v9 offset:37632
    v_mfma_f32_16x16x32_bf16 v[148:151], a[244:247], v[84:87], v[148:151]
    ds_read_b64_tr_b16 a[232:233], v10 offset:36896
    ds_read_b64_tr_b16 a[234:235], v10 offset:37664
    ds_read_b64_tr_b16 a[204:205], v9 offset:36928
    v_mfma_f32_16x16x32_bf16 v[152:155], a[216:219], v[84:87], v[152:155]
    ds_read_b64_tr_b16 a[206:207], v9 offset:37696
    ds_read_b64_tr_b16 a[236:237], v10 offset:36960
    ds_read_b64_tr_b16 a[238:239], v10 offset:37728
    v_mfma_f32_16x16x32_bf16 v[156:159], a[248:251], v[84:87], v[156:159]
    ds_read_b64_tr_b16 a[208:209], v9 offset:36992
    ds_read_b64_tr_b16 a[210:211], v9 offset:37760
    s_add_u32 m0, s55, 12160
    ds_read_b64_tr_b16 a[240:241], v10 offset:37024
    buffer_load_dwordx4 v171, s[4:7], s87 offen offset:128 lds
    v_mfma_f32_16x16x32_bf16 v[160:163], a[220:223], v[84:87], v[160:163]
    ds_read_b64_tr_b16 a[242:243], v10 offset:37792
    buffer_load_dwordx4 v172, s[4:7], s87 offen offset:1152 lds
    v_mfma_f32_16x16x32_bf16 v[164:167], a[252:255], v[84:87], v[164:167]
    s_add_u32 m0, s60, 24576
    s_add_u32 s73, s89, 1181184
    buffer_load_dwordx4 v4, s[8:11], s73 offen lds
    s_waitcnt lgkmcnt(0)
    v_mfma_f32_16x16x32_bf16 v[144:147], a[200:203], v[88:91], v[144:147]
    ds_read_b128 v[92:95], v173 offset:6144
    ds_read_b64_tr_b16 a[212:213], v9 offset:43008
    ds_read_b64_tr_b16 a[214:215], v9 offset:43776
    v_mfma_f32_16x16x32_bf16 v[148:151], a[232:235], v[88:91], v[148:151]
    ds_read_b64_tr_b16 a[244:245], v10 offset:43040
    ds_read_b64_tr_b16 a[246:247], v10 offset:43808
    ds_read_b64_tr_b16 a[216:217], v9 offset:43072
    v_mfma_f32_16x16x32_bf16 v[152:155], a[204:207], v[88:91], v[152:155]
    ds_read_b64_tr_b16 a[218:219], v9 offset:43840
    ds_read_b64_tr_b16 a[248:249], v10 offset:43104
    ds_read_b64_tr_b16 a[250:251], v10 offset:43872
    v_mfma_f32_16x16x32_bf16 v[156:159], a[236:239], v[88:91], v[156:159]
    ds_read_b64_tr_b16 a[220:221], v9 offset:43136
    ds_read_b64_tr_b16 a[222:223], v9 offset:43904
    ds_read_b64_tr_b16 a[252:253], v10 offset:43168
    buffer_load_dwordx4 v5, s[8:11], s73 offen offset:1024 lds
    v_mfma_f32_16x16x32_bf16 v[160:163], a[208:211], v[88:91], v[160:163]
    ds_read_b64_tr_b16 a[254:255], v10 offset:43936
    buffer_load_dwordx4 v6, s[8:11], s73 offen offset:2048 lds
    v_mfma_f32_16x16x32_bf16 v[164:167], a[240:243], v[88:91], v[164:167]
    s_lshl_b32 s70, s2, 2
    s_add_u32 s70, s70, s50
    s_mul_i32 s70, s70, 60
    v_add_u32 v204, s70, v0
    v_mul_u32_u24 v205, 43691, v204
    v_lshrrev_b32 v205, 22, v205
    v_mul_u32_u24 v205, 1536, v205
    v_lshl_add_u32 v204, v204, 4, v205
    s_mov_b32 exec_hi, 0xfffffff
    buffer_load_dwordx4 v[204:207], v204, s[8:11], 0 offen offset:0
    s_mov_b64 exec, -1
    v_mul_u32_u24 v179, 2731, v181
    v_lshrrev_b32 v179, 16, v179
    v_mul_u32_u24 v180, 24, v179
    v_sub_u32 v178, v181, v180
    v_bfe_u32 v180, v179, 1, 3
    v_xor_b32 v178, v178, v180
    v_mul_u32_u24 v179, 1280, v179
    v_lshl_add_u32 v178, v178, 4, v179
    s_waitcnt vmcnt(11) lgkmcnt(0)
    s_barrier
    v_mfma_f32_16x16x32_bf16 v[144:147], a[212:215], v[92:95], v[144:147]
    ds_read_b128 v[96:99], v170 offset:8192
    ds_read_b64_tr_b16 a[200:201], v9 offset:0
    ds_read_b64_tr_b16 a[202:203], v9 offset:768
    v_mfma_f32_16x16x32_bf16 v[148:151], a[244:247], v[92:95], v[148:151]
    ds_read_b64_tr_b16 a[232:233], v10 offset:32
    ds_read_b64_tr_b16 a[234:235], v10 offset:800
    ds_read_b64_tr_b16 a[204:205], v9 offset:64
    v_mfma_f32_16x16x32_bf16 v[152:155], a[216:219], v[92:95], v[152:155]
    ds_read_b64_tr_b16 a[206:207], v9 offset:832
    ds_read_b64_tr_b16 a[236:237], v10 offset:96
    ds_read_b64_tr_b16 a[238:239], v10 offset:864
    v_mfma_f32_16x16x32_bf16 v[156:159], a[248:251], v[92:95], v[156:159]
    ds_read_b64_tr_b16 a[208:209], v9 offset:128
    ds_read_b64_tr_b16 a[210:211], v9 offset:896
    s_add_u32 m0, s55, 14080
    ds_read_b64_tr_b16 a[240:241], v10 offset:160
    buffer_load_dwordx4 v171, s[4:7], s87 offen offset:256 lds
    v_mfma_f32_16x16x32_bf16 v[160:163], a[220:223], v[92:95], v[160:163]
    ds_read_b64_tr_b16 a[242:243], v10 offset:928
    buffer_load_dwordx4 v172, s[4:7], s87 offen offset:1280 lds
    v_mfma_f32_16x16x32_bf16 v[164:167], a[252:255], v[92:95], v[164:167]
    s_add_u32 m0, s60, 36864
    s_add_u32 s73, s89, 1377792
    buffer_load_dwordx4 v4, s[8:11], s73 offen lds
    s_waitcnt lgkmcnt(0)
    v_mfma_f32_16x16x32_bf16 v[144:147], a[200:203], v[96:99], v[144:147]
    ds_read_b128 v[100:103], v173 offset:8192
    ds_read_b64_tr_b16 a[212:213], v9 offset:6144
    ds_read_b64_tr_b16 a[214:215], v9 offset:6912
    v_mfma_f32_16x16x32_bf16 v[148:151], a[232:235], v[96:99], v[148:151]
    ds_read_b64_tr_b16 a[244:245], v10 offset:6176
    ds_read_b64_tr_b16 a[246:247], v10 offset:6944
    ds_read_b64_tr_b16 a[216:217], v9 offset:6208
    v_mfma_f32_16x16x32_bf16 v[152:155], a[204:207], v[96:99], v[152:155]
    ds_read_b64_tr_b16 a[218:219], v9 offset:6976
    ds_read_b64_tr_b16 a[248:249], v10 offset:6240
    ds_read_b64_tr_b16 a[250:251], v10 offset:7008
    v_mfma_f32_16x16x32_bf16 v[156:159], a[236:239], v[96:99], v[156:159]
    ds_read_b64_tr_b16 a[220:221], v9 offset:6272
    ds_read_b64_tr_b16 a[222:223], v9 offset:7040
    ds_read_b64_tr_b16 a[252:253], v10 offset:6304
    buffer_load_dwordx4 v5, s[8:11], s73 offen offset:1024 lds
    v_mfma_f32_16x16x32_bf16 v[160:163], a[208:211], v[96:99], v[160:163]
    ds_read_b64_tr_b16 a[254:255], v10 offset:7072
    buffer_load_dwordx4 v6, s[8:11], s73 offen offset:2048 lds
    v_mfma_f32_16x16x32_bf16 v[164:167], a[240:243], v[96:99], v[164:167]
    v_lshrrev_b32 v176, 2, v0
    v_mul_u32_u24 v176, 160, v176
    v_and_b32 v177, 3, v0
    v_lshl_add_u32 v176, v177, 3, v176
    v_add_u32 v176, 131072, v176
    s_lshl_b32 s68, s50, 5
    v_add_u32 v177, s68, v176
    ds_read_b64_tr_b16 v[248:249], v177 offset:0
    ds_read_b64_tr_b16 v[250:251], v177 offset:2560
    ds_read_b64_tr_b16 v[252:253], v176 offset:128
    ds_read_b64_tr_b16 v[254:255], v176 offset:2688
    s_waitcnt vmcnt(11) lgkmcnt(0)
    s_barrier
    v_mfma_f32_16x16x32_bf16 v[144:147], a[212:215], v[100:103], v[144:147]
    ds_read_b128 v[104:107], v170 offset:10240
    ds_read_b64_tr_b16 a[200:201], v9 offset:12288
    ds_read_b64_tr_b16 a[202:203], v9 offset:13056
    v_mfma_f32_16x16x32_bf16 v[148:151], a[244:247], v[100:103], v[148:151]
    ds_read_b64_tr_b16 a[232:233], v10 offset:12320
    ds_read_b64_tr_b16 a[234:235], v10 offset:13088
    ds_read_b64_tr_b16 a[204:205], v9 offset:12352
    v_mfma_f32_16x16x32_bf16 v[152:155], a[216:219], v[100:103], v[152:155]
    ds_read_b64_tr_b16 a[206:207], v9 offset:13120
    ds_read_b64_tr_b16 a[236:237], v10 offset:12384
    ds_read_b64_tr_b16 a[238:239], v10 offset:13152
    v_mfma_f32_16x16x32_bf16 v[156:159], a[248:251], v[100:103], v[156:159]
    ds_read_b64_tr_b16 a[208:209], v9 offset:12416
    ds_read_b64_tr_b16 a[210:211], v9 offset:13184
    s_add_u32 m0, s55, 16000
    ds_read_b64_tr_b16 a[240:241], v10 offset:12448
    buffer_load_dwordx4 v171, s[4:7], s87 offen offset:384 lds
    v_mfma_f32_16x16x32_bf16 v[160:163], a[220:223], v[100:103], v[160:163]
    ds_read_b64_tr_b16 a[242:243], v10 offset:13216
    buffer_load_dwordx4 v172, s[4:7], s87 offen offset:1408 lds
    v_mfma_f32_16x16x32_bf16 v[164:167], a[252:255], v[100:103], v[164:167]
    s_add_u32 m0, s60, 0
    s_add_u32 s73, s89, 1574400
    buffer_load_dwordx4 v4, s[8:11], s73 offen lds
    s_waitcnt lgkmcnt(0)
    v_mfma_f32_16x16x32_bf16 v[144:147], a[200:203], v[104:107], v[144:147]
    ds_read_b128 v[108:111], v173 offset:10240
    ds_read_b64_tr_b16 a[212:213], v9 offset:18432
    ds_read_b64_tr_b16 a[214:215], v9 offset:19200
    v_mfma_f32_16x16x32_bf16 v[148:151], a[232:235], v[104:107], v[148:151]
    ds_read_b64_tr_b16 a[244:245], v10 offset:18464
    ds_read_b64_tr_b16 a[246:247], v10 offset:19232
    ds_read_b64_tr_b16 a[216:217], v9 offset:18496
    v_mfma_f32_16x16x32_bf16 v[152:155], a[204:207], v[104:107], v[152:155]
    ds_read_b64_tr_b16 a[218:219], v9 offset:19264
    ds_read_b64_tr_b16 a[248:249], v10 offset:18528
    ds_read_b64_tr_b16 a[250:251], v10 offset:19296
    v_mfma_f32_16x16x32_bf16 v[156:159], a[236:239], v[104:107], v[156:159]
    ds_read_b64_tr_b16 a[220:221], v9 offset:18560
    ds_read_b64_tr_b16 a[222:223], v9 offset:19328
    ds_read_b64_tr_b16 a[252:253], v10 offset:18592
    buffer_load_dwordx4 v5, s[8:11], s73 offen offset:1024 lds
    v_mfma_f32_16x16x32_bf16 v[160:163], a[208:211], v[104:107], v[160:163]
    ds_read_b64_tr_b16 a[254:255], v10 offset:19360
    buffer_load_dwordx4 v6, s[8:11], s73 offen offset:2048 lds
    s_add_u32 m0, s84, 131072
    v_mfma_f32_16x16x32_bf16 v[164:167], a[240:243], v[104:107], v[164:167]
    buffer_load_dwordx4 v178, s[20:23], s76 offen lds
    v_add_u32 v181, 64, v181
    v_mul_u32_u24 v179, 2731, v181
    v_lshrrev_b32 v179, 16, v179
    v_mul_u32_u24 v180, 24, v179
    v_sub_u32 v178, v181, v180
    v_bfe_u32 v180, v179, 1, 3
    v_xor_b32 v178, v178, v180
    v_mul_u32_u24 v179, 1280, v179
    v_lshl_add_u32 v178, v178, 4, v179
    v_subrev_u32 v178, 1024, v178
    buffer_load_dwordx4 v178, s[20:23], s76 offen offset:1024 lds
    v_add_u32 v181, 64, v181
    v_mul_u32_u24 v179, 2731, v181
    v_lshrrev_b32 v179, 16, v179
    v_mul_u32_u24 v180, 24, v179
    v_sub_u32 v178, v181, v180
    v_bfe_u32 v180, v179, 1, 3
    v_xor_b32 v178, v178, v180
    v_mul_u32_u24 v179, 1280, v179
    v_lshl_add_u32 v178, v178, 4, v179
    v_subrev_u32 v178, 2048, v178
    buffer_load_dwordx4 v178, s[20:23], s76 offen offset:2048 lds
    v_add_u32 v181, 64, v181
    v_mul_u32_u24 v179, 2731, v181
    v_lshrrev_b32 v179, 16, v179
    v_mul_u32_u24 v180, 24, v179
    v_sub_u32 v178, v181, v180
    v_bfe_u32 v180, v179, 1, 3
    v_xor_b32 v178, v178, v180
    v_mul_u32_u24 v179, 1280, v179
    v_lshl_add_u32 v178, v178, 4, v179
    v_subrev_u32 v178, 3072, v178
    buffer_load_dwordx4 v178, s[20:23], s76 offen offset:3072 lds
    v_add_u32 v181, 64, v181
    v_mul_u32_u24 v179, 2731, v181
    v_lshrrev_b32 v179, 16, v179
    v_mul_u32_u24 v180, 24, v179
    v_sub_u32 v178, v181, v180
    v_bfe_u32 v180, v179, 1, 3
    v_xor_b32 v178, v178, v180
    v_mul_u32_u24 v179, 1280, v179
    s_add_u32 m0, s84, 135168
    v_lshl_add_u32 v178, v178, 4, v179
    buffer_load_dwordx4 v178, s[20:23], s76 offen lds
    v_add_u32 v181, 64, v181
    v_mul_u32_u24 v179, 2731, v181
    v_lshrrev_b32 v179, 16, v179
    v_mul_u32_u24 v180, 24, v179
    s_waitcnt vmcnt(16) lgkmcnt(0)
    s_barrier
    v_mfma_f32_16x16x32_bf16 v[144:147], a[212:215], v[108:111], v[144:147]
    ds_read_b128 v[112:115], v170 offset:12288
    ds_read_b64_tr_b16 a[200:201], v9 offset:24576
    ds_read_b64_tr_b16 a[202:203], v9 offset:25344
    v_mfma_f32_16x16x32_bf16 v[148:151], a[244:247], v[108:111], v[148:151]
    ds_read_b64_tr_b16 a[232:233], v10 offset:24608
    ds_read_b64_tr_b16 a[234:235], v10 offset:25376
    ds_read_b64_tr_b16 a[204:205], v9 offset:24640
    v_mfma_f32_16x16x32_bf16 v[152:155], a[216:219], v[108:111], v[152:155]
    ds_read_b64_tr_b16 a[206:207], v9 offset:25408
    ds_read_b64_tr_b16 a[236:237], v10 offset:24672
    ds_read_b64_tr_b16 a[238:239], v10 offset:25440
    v_mfma_f32_16x16x32_bf16 v[156:159], a[248:251], v[108:111], v[156:159]
    ds_read_b64_tr_b16 a[208:209], v9 offset:24704
    ds_read_b64_tr_b16 a[210:211], v9 offset:25472
    s_add_u32 m0, s55, 17920
    ds_read_b64_tr_b16 a[240:241], v10 offset:24736
    buffer_load_dwordx4 v171, s[4:7], s87 offen offset:512 lds
    v_mfma_f32_16x16x32_bf16 v[160:163], a[220:223], v[108:111], v[160:163]
    ds_read_b64_tr_b16 a[242:243], v10 offset:25504
    buffer_load_dwordx4 v172, s[4:7], s87 offen offset:1536 lds
    v_mfma_f32_16x16x32_bf16 v[164:167], a[252:255], v[108:111], v[164:167]
    s_add_u32 m0, s60, 12288
    s_add_u32 s73, s89, 1771008
    buffer_load_dwordx4 v4, s[8:11], s73 offen lds
    s_waitcnt lgkmcnt(0)
    v_mfma_f32_16x16x32_bf16 v[144:147], a[200:203], v[112:115], v[144:147]
    ds_read_b128 v[116:119], v173 offset:12288
    ds_read_b64_tr_b16 a[212:213], v9 offset:30720
    ds_read_b64_tr_b16 a[214:215], v9 offset:31488
    v_mfma_f32_16x16x32_bf16 v[148:151], a[232:235], v[112:115], v[148:151]
    ds_read_b64_tr_b16 a[244:245], v10 offset:30752
    ds_read_b64_tr_b16 a[246:247], v10 offset:31520
    ds_read_b64_tr_b16 a[216:217], v9 offset:30784
    v_mfma_f32_16x16x32_bf16 v[152:155], a[204:207], v[112:115], v[152:155]
    ds_read_b64_tr_b16 a[218:219], v9 offset:31552
    ds_read_b64_tr_b16 a[248:249], v10 offset:30816
    ds_read_b64_tr_b16 a[250:251], v10 offset:31584
    v_mfma_f32_16x16x32_bf16 v[156:159], a[236:239], v[112:115], v[156:159]
    ds_read_b64_tr_b16 a[220:221], v9 offset:30848
    ds_read_b64_tr_b16 a[222:223], v9 offset:31616
    ds_read_b64_tr_b16 a[252:253], v10 offset:30880
    buffer_load_dwordx4 v5, s[8:11], s73 offen offset:1024 lds
    v_mfma_f32_16x16x32_bf16 v[160:163], a[208:211], v[112:115], v[160:163]
    ds_read_b64_tr_b16 a[254:255], v10 offset:31648
    buffer_load_dwordx4 v6, s[8:11], s73 offen offset:2048 lds
    v_mfma_f32_16x16x32_bf16 v[164:167], a[240:243], v[112:115], v[164:167]
    v_sub_u32 v178, v181, v180
    v_bfe_u32 v180, v179, 1, 3
    v_xor_b32 v178, v178, v180
    v_mul_u32_u24 v179, 1280, v179
    v_lshl_add_u32 v178, v178, 4, v179
    s_add_u32 m0, s84, 135168
    v_subrev_u32 v178, 1024, v178
    buffer_load_dwordx4 v178, s[20:23], s76 offen offset:1024 lds
    v_add_u32 v181, 64, v181
    v_mul_u32_u24 v179, 2731, v181
    v_lshrrev_b32 v179, 16, v179
    v_mul_u32_u24 v180, 24, v179
    v_sub_u32 v178, v181, v180
    v_bfe_u32 v180, v179, 1, 3
    v_xor_b32 v178, v178, v180
    v_mul_u32_u24 v179, 1280, v179
    v_lshl_add_u32 v178, v178, 4, v179
    v_subrev_u32 v178, 2048, v178
    buffer_load_dwordx4 v178, s[20:23], s76 offen offset:2048 lds
    v_add_u32 v181, 64, v181
    v_mul_u32_u24 v179, 2731, v181
    v_lshrrev_b32 v179, 16, v179
    v_mul_u32_u24 v180, 24, v179
    v_sub_u32 v178, v181, v180
    v_bfe_u32 v180, v179, 1, 3
    v_xor_b32 v178, v178, v180
    v_mul_u32_u24 v179, 1280, v179
    v_lshl_add_u32 v178, v178, 4, v179
    v_subrev_u32 v178, 3072, v178
    buffer_load_dwordx4 v178, s[20:23], s76 offen offset:3072 lds
    s_waitcnt vmcnt(18) lgkmcnt(0)
    s_barrier
    v_mfma_f32_16x16x32_bf16 v[144:147], a[212:215], v[116:119], v[144:147]
    ds_read_b128 v[120:123], v170 offset:14336
    ds_read_b64_tr_b16 a[200:201], v9 offset:36864
    ds_read_b64_tr_b16 a[202:203], v9 offset:37632
    v_mfma_f32_16x16x32_bf16 v[148:151], a[244:247], v[116:119], v[148:151]
    ds_read_b64_tr_b16 a[232:233], v10 offset:36896
    ds_read_b64_tr_b16 a[234:235], v10 offset:37664
    ds_read_b64_tr_b16 a[204:205], v9 offset:36928
    v_mfma_f32_16x16x32_bf16 v[152:155], a[216:219], v[116:119], v[152:155]
    ds_read_b64_tr_b16 a[206:207], v9 offset:37696
    ds_read_b64_tr_b16 a[236:237], v10 offset:36960
    ds_read_b64_tr_b16 a[238:239], v10 offset:37728
    v_mfma_f32_16x16x32_bf16 v[156:159], a[248:251], v[116:119], v[156:159]
    ds_read_b64_tr_b16 a[208:209], v9 offset:36992
    ds_read_b64_tr_b16 a[210:211], v9 offset:37760
    ds_read_b64_tr_b16 a[240:241], v10 offset:37024
    s_add_u32 m0, s55, 0
    s_xor_b32 s74, s61, 0
    buffer_load_dwordx4 v16, s[12:15], s74 offen lds
    v_mfma_f32_16x16x32_bf16 v[160:163], a[220:223], v[116:119], v[160:163]
    ds_read_b64_tr_b16 a[242:243], v10 offset:37792
    buffer_load_dwordx4 v17, s[12:15], s74 offen offset:1024 lds
    v_mfma_f32_16x16x32_bf16 v[164:167], a[252:255], v[116:119], v[164:167]
    s_waitcnt lgkmcnt(0)
    v_mfma_f32_16x16x32_bf16 v[144:147], a[200:203], v[120:123], v[144:147]
    ds_read_b128 v[124:127], v173 offset:14336
    ds_read_b64_tr_b16 a[212:213], v9 offset:43008
    ds_read_b64_tr_b16 a[214:215], v9 offset:43776
    v_mfma_f32_16x16x32_bf16 v[148:151], a[232:235], v[120:123], v[148:151]
    ds_read_b64_tr_b16 a[244:245], v10 offset:43040
    ds_read_b64_tr_b16 a[246:247], v10 offset:43808
    ds_read_b64_tr_b16 a[216:217], v9 offset:43072
    v_mfma_f32_16x16x32_bf16 v[152:155], a[204:207], v[120:123], v[152:155]
    ds_read_b64_tr_b16 a[218:219], v9 offset:43840
    ds_read_b64_tr_b16 a[248:249], v10 offset:43104
    ds_read_b64_tr_b16 a[250:251], v10 offset:43872
    v_mfma_f32_16x16x32_bf16 v[156:159], a[236:239], v[120:123], v[156:159]
    ds_read_b64_tr_b16 a[220:221], v9 offset:43136
    ds_read_b64_tr_b16 a[222:223], v9 offset:43904
    ds_read_b64_tr_b16 a[252:253], v10 offset:43168
    s_add_u32 m0, s55, 2048
    s_xor_b32 s74, s62, 0
    buffer_load_dwordx4 v16, s[12:15], s74 offen lds
    v_mfma_f32_16x16x32_bf16 v[160:163], a[208:211], v[120:123], v[160:163]
    ds_read_b64_tr_b16 a[254:255], v10 offset:43936
    buffer_load_dwordx4 v17, s[12:15], s74 offen offset:1024 lds
    v_mfma_f32_16x16x32_bf16 v[164:167], a[240:243], v[120:123], v[164:167]
    s_waitcnt vmcnt(17) lgkmcnt(0)
    s_barrier
    v_mfma_f32_16x16x32_bf16 v[144:147], a[212:215], v[124:127], v[144:147]
    ds_read_b128 v[128:131], v170 offset:16384
    ds_read_b64_tr_b16 a[200:201], v9 offset:0
    ds_read_b64_tr_b16 a[202:203], v9 offset:768
    v_mfma_f32_16x16x32_bf16 v[148:151], a[244:247], v[124:127], v[148:151]
    ds_read_b64_tr_b16 a[232:233], v10 offset:32
    ds_read_b64_tr_b16 a[234:235], v10 offset:800
    ds_read_b64_tr_b16 a[204:205], v9 offset:64
    v_mfma_f32_16x16x32_bf16 v[152:155], a[216:219], v[124:127], v[152:155]
    ds_read_b64_tr_b16 a[206:207], v9 offset:832
    ds_read_b64_tr_b16 a[236:237], v10 offset:96
    ds_read_b64_tr_b16 a[238:239], v10 offset:864
    v_mfma_f32_16x16x32_bf16 v[156:159], a[248:251], v[124:127], v[156:159]
    ds_read_b64_tr_b16 a[208:209], v9 offset:128
    ds_read_b64_tr_b16 a[210:211], v9 offset:896
    ds_read_b64_tr_b16 a[240:241], v10 offset:160
    s_mul_i32 s68, s50, 320
    s_add_u32 m0, s68, 129536
    s_mov_b64 exec, 0xfffff
    buffer_load_dwordx4 v2, s[36:39], s68 offen lds
    s_mov_b64 exec, -1
    v_mfma_f32_16x16x32_bf16 v[160:163], a[220:223], v[124:127], v[160:163]
    ds_read_b64_tr_b16 a[242:243], v10 offset:928
    s_add_u32 m0, s55, 4096
    s_xor_b32 s74, s63, 0
    buffer_load_dwordx4 v16, s[12:15], s74 offen lds
    v_mfma_f32_16x16x32_bf16 v[164:167], a[252:255], v[124:127], v[164:167]
    buffer_load_dwordx4 v17, s[12:15], s74 offen offset:1024 lds
    s_waitcnt lgkmcnt(0)
    v_mfma_f32_16x16x32_bf16 v[144:147], a[200:203], v[128:131], v[144:147]
    ds_read_b128 v[132:135], v173 offset:16384
    ds_read_b64_tr_b16 a[212:213], v9 offset:6144
    ds_read_b64_tr_b16 a[214:215], v9 offset:6912
    v_mfma_f32_16x16x32_bf16 v[148:151], a[232:235], v[128:131], v[148:151]
    ds_read_b64_tr_b16 a[244:245], v10 offset:6176
    ds_read_b64_tr_b16 a[246:247], v10 offset:6944
    ds_read_b64_tr_b16 a[216:217], v9 offset:6208
    v_mfma_f32_16x16x32_bf16 v[152:155], a[204:207], v[128:131], v[152:155]
    ds_read_b64_tr_b16 a[218:219], v9 offset:6976
    ds_read_b64_tr_b16 a[248:249], v10 offset:6240
    ds_read_b64_tr_b16 a[250:251], v10 offset:7008
    v_mfma_f32_16x16x32_bf16 v[156:159], a[236:239], v[128:131], v[156:159]
    ds_read_b64_tr_b16 a[220:221], v9 offset:6272
    ds_read_b64_tr_b16 a[222:223], v9 offset:7040
    ds_read_b64_tr_b16 a[252:253], v10 offset:6304
    s_add_u32 m0, s55, 6144
    s_xor_b32 s74, s64, 0
    buffer_load_dwordx4 v16, s[12:15], s74 offen lds
    v_mfma_f32_16x16x32_bf16 v[160:163], a[208:211], v[128:131], v[160:163]
    ds_read_b64_tr_b16 a[254:255], v10 offset:7072
    buffer_load_dwordx4 v17, s[12:15], s74 offen offset:1024 lds
    v_mfma_f32_16x16x32_bf16 v[164:167], a[240:243], v[128:131], v[164:167]
    s_waitcnt vmcnt(12) lgkmcnt(0)
    s_barrier
    v_mfma_f32_16x16x32_bf16 v[144:147], a[212:215], v[132:135], v[144:147]
    ds_read_b128 v[136:139], v170 offset:18432
    ds_read_b64_tr_b16 a[200:201], v9 offset:12288
    ds_read_b64_tr_b16 a[202:203], v9 offset:13056
    v_mfma_f32_16x16x32_bf16 v[148:151], a[244:247], v[132:135], v[148:151]
    ds_read_b64_tr_b16 a[232:233], v10 offset:12320
    ds_read_b64_tr_b16 a[234:235], v10 offset:13088
    ds_read_b64_tr_b16 a[204:205], v9 offset:12352
    v_mfma_f32_16x16x32_bf16 v[152:155], a[216:219], v[132:135], v[152:155]
    ds_read_b64_tr_b16 a[206:207], v9 offset:13120
    ds_read_b64_tr_b16 a[236:237], v10 offset:12384
    ds_read_b64_tr_b16 a[238:239], v10 offset:13152
    v_mfma_f32_16x16x32_bf16 v[156:159], a[248:251], v[132:135], v[156:159]
    ds_read_b64_tr_b16 a[208:209], v9 offset:12416
    ds_read_b64_tr_b16 a[210:211], v9 offset:13184
    ds_read_b64_tr_b16 a[240:241], v10 offset:12448
    s_add_u32 m0, s55, 8192
    s_xor_b32 s74, s61, 128
    buffer_load_dwordx4 v16, s[12:15], s74 offen lds
    v_mfma_f32_16x16x32_bf16 v[160:163], a[220:223], v[132:135], v[160:163]
    ds_read_b64_tr_b16 a[242:243], v10 offset:13216
    buffer_load_dwordx4 v17, s[12:15], s74 offen offset:1024 lds
    v_mfma_f32_16x16x32_bf16 v[164:167], a[252:255], v[132:135], v[164:167]
    s_waitcnt lgkmcnt(0)
    v_mfma_f32_16x16x32_bf16 v[144:147], a[200:203], v[136:139], v[144:147]
    ds_read_b128 v[140:143], v173 offset:18432
    ds_read_b64_tr_b16 a[212:213], v9 offset:18432
    ds_read_b64_tr_b16 a[214:215], v9 offset:19200
    v_mfma_f32_16x16x32_bf16 v[148:151], a[232:235], v[136:139], v[148:151]
    ds_read_b64_tr_b16 a[244:245], v10 offset:18464
    ds_read_b64_tr_b16 a[246:247], v10 offset:19232
    ds_read_b64_tr_b16 a[216:217], v9 offset:18496
    v_mfma_f32_16x16x32_bf16 v[152:155], a[204:207], v[136:139], v[152:155]
    ds_read_b64_tr_b16 a[218:219], v9 offset:19264
    ds_read_b64_tr_b16 a[248:249], v10 offset:18528
    ds_read_b64_tr_b16 a[250:251], v10 offset:19296
    v_mfma_f32_16x16x32_bf16 v[156:159], a[236:239], v[136:139], v[156:159]
    ds_read_b64_tr_b16 a[220:221], v9 offset:18560
    ds_read_b64_tr_b16 a[222:223], v9 offset:19328
    ds_read_b64_tr_b16 a[252:253], v10 offset:18592
    s_add_u32 m0, s55, 10240
    s_xor_b32 s74, s62, 128
    buffer_load_dwordx4 v16, s[12:15], s74 offen lds
    v_mfma_f32_16x16x32_bf16 v[160:163], a[208:211], v[136:139], v[160:163]
    ds_read_b64_tr_b16 a[254:255], v10 offset:19360
    buffer_load_dwordx4 v17, s[12:15], s74 offen offset:1024 lds
    v_mfma_f32_16x16x32_bf16 v[164:167], a[240:243], v[136:139], v[164:167]
    s_waitcnt lgkmcnt(0)
    v_mfma_f32_16x16x32_bf16 v[144:147], a[212:215], v[140:143], v[144:147]
    v_mfma_f32_16x16x32_bf16 v[148:151], a[244:247], v[140:143], v[148:151]
    v_mfma_f32_16x16x32_bf16 v[152:155], a[216:219], v[140:143], v[152:155]
    v_mfma_f32_16x16x32_bf16 v[156:159], a[248:251], v[140:143], v[156:159]
    v_mfma_f32_16x16x32_bf16 v[160:163], a[220:223], v[140:143], v[160:163]
    v_mfma_f32_16x16x32_bf16 v[164:167], a[252:255], v[140:143], v[164:167]
    s_nop 0
    s_waitcnt vmcnt(9)
    ds_read_b128 a[0:3], v18 offset:0
    ds_read_b128 a[32:35], v19 offset:0
    s_add_u32 m0, s60, 0
    s_add_u32 s73, s59, 0
    buffer_load_dwordx4 v4, s[8:11], s73 offen lds
    v_pk_mul_f32 v[168:169], v[144:145], v[144:145]
    ds_read_b128 a[4:7], v18 offset:2048
    ds_read_b128 a[36:39], v19 offset:2048
    v_pk_mul_f32 v[170:171], v[146:147], v[146:147]
    v_pk_mul_f32 v[172:173], v[148:149], v[148:149]
    v_pk_mul_f32 v[174:175], v[150:151], v[150:151]
    v_pk_fma_f32 v[168:169], v[168:169], v[20:21], v[20:21] op_sel:[0,1,0] op_sel_hi:[1,1,0]
    v_pk_fma_f32 v[170:171], v[170:171], v[20:21], v[20:21] op_sel:[0,1,0] op_sel_hi:[1,1,0]
    v_pk_fma_f32 v[172:173], v[172:173], v[20:21], v[20:21] op_sel:[0,1,0] op_sel_hi:[1,1,0]
    v_pk_fma_f32 v[174:175], v[174:175], v[20:21], v[20:21] op_sel:[0,1,0] op_sel_hi:[1,1,0]
    v_pk_mul_f32 v[168:169], v[168:169], v[144:145]
    buffer_load_dwordx4 v5, s[8:11], s73 offen offset:1024 lds
    v_pk_mul_f32 v[170:171], v[170:171], v[146:147]
    v_pk_mul_f32 v[172:173], v[172:173], v[148:149]
    v_pk_mul_f32 v[174:175], v[174:175], v[150:151]
    v_exp_f32 v168, v168
    v_exp_f32 v169, v169
    v_exp_f32 v170, v170
    v_exp_f32 v171, v171
    v_exp_f32 v172, v172
    v_exp_f32 v173, v173
    buffer_load_dwordx4 v6, s[8:11], s73 offen offset:2048 lds
    v_exp_f32 v174, v174
    v_exp_f32 v175, v175
    v_pk_add_f32 v[168:169], v[168:169], 1.0 op_sel_hi:[1,0]
    v_pk_add_f32 v[170:171], v[170:171], 1.0 op_sel_hi:[1,0]
    v_pk_add_f32 v[172:173], v[172:173], 1.0 op_sel_hi:[1,0]
    v_pk_add_f32 v[174:175], v[174:175], 1.0 op_sel_hi:[1,0]
    v_rcp_f32 v168, v168
    v_rcp_f32 v169, v169
    v_rcp_f32 v170, v170
    s_add_u32 m0, s55, 12288
    s_xor_b32 s74, s63, 128
    buffer_load_dwordx4 v16, s[12:15], s74 offen lds
    v_rcp_f32 v171, v171
    v_rcp_f32 v172, v172
    v_rcp_f32 v173, v173
    v_rcp_f32 v174, v174
    v_rcp_f32 v175, v175
    v_pk_mul_f32 v[144:145], v[144:145], v[168:169]
    v_pk_mul_f32 v[146:147], v[146:147], v[170:171]
    v_pk_mul_f32 v[148:149], v[148:149], v[172:173]
    v_pk_mul_f32 v[150:151], v[150:151], v[174:175]
    buffer_load_dwordx4 v17, s[12:15], s74 offen offset:1024 lds
    v_pk_mul_f32 v[168:169], v[152:153], v[152:153]
    v_pk_mul_f32 v[170:171], v[154:155], v[154:155]
    v_pk_mul_f32 v[172:173], v[156:157], v[156:157]
    v_pk_mul_f32 v[174:175], v[158:159], v[158:159]
    v_pk_fma_f32 v[168:169], v[168:169], v[20:21], v[20:21] op_sel:[0,1,0] op_sel_hi:[1,1,0]
    v_pk_fma_f32 v[170:171], v[170:171], v[20:21], v[20:21] op_sel:[0,1,0] op_sel_hi:[1,1,0]
    v_pk_fma_f32 v[172:173], v[172:173], v[20:21], v[20:21] op_sel:[0,1,0] op_sel_hi:[1,1,0]
    v_pk_fma_f32 v[174:175], v[174:175], v[20:21], v[20:21] op_sel:[0,1,0] op_sel_hi:[1,1,0]
    v_pk_mul_f32 v[168:169], v[168:169], v[152:153]
    v_pk_mul_f32 v[170:171], v[170:171], v[154:155]
    v_pk_mul_f32 v[172:173], v[172:173], v[156:157]
    v_pk_mul_f32 v[174:175], v[174:175], v[158:159]
    s_add_u32 m0, s55, 14336
    s_xor_b32 s74, s64, 128
    buffer_load_dwordx4 v16, s[12:15], s74 offen lds
    v_exp_f32 v168, v168
    s_waitcnt vmcnt(10)
    ds_read_b128 a[8:11], v18 offset:4096
    ds_read_b128 a[40:43], v19 offset:4096
    v_exp_f32 v169, v169
    ds_read_b128 a[12:15], v18 offset:6144
    ds_read_b128 a[44:47], v19 offset:6144
    v_exp_f32 v170, v170
    v_exp_f32 v171, v171
    v_exp_f32 v172, v172
    buffer_load_dwordx4 v17, s[12:15], s74 offen offset:1024 lds
    v_exp_f32 v173, v173
    v_exp_f32 v174, v174
    v_exp_f32 v175, v175
    v_pk_add_f32 v[168:169], v[168:169], 1.0 op_sel_hi:[1,0]
    v_pk_add_f32 v[170:171], v[170:171], 1.0 op_sel_hi:[1,0]
    v_pk_add_f32 v[172:173], v[172:173], 1.0 op_sel_hi:[1,0]
    v_pk_add_f32 v[174:175], v[174:175], 1.0 op_sel_hi:[1,0]
    v_rcp_f32 v168, v168
    v_rcp_f32 v169, v169
    s_add_u32 m0, s55, 16384
    s_xor_b32 s74, s61, 256
    buffer_load_dwordx4 v16, s[12:15], s74 offen lds
    v_rcp_f32 v170, v170
    v_rcp_f32 v171, v171
    v_rcp_f32 v172, v172
    v_rcp_f32 v173, v173
    v_rcp_f32 v174, v174
    v_rcp_f32 v175, v175
    v_pk_mul_f32 v[152:153], v[152:153], v[168:169]
    v_pk_mul_f32 v[154:155], v[154:155], v[170:171]
    v_pk_mul_f32 v[156:157], v[156:157], v[172:173]
    buffer_load_dwordx4 v17, s[12:15], s74 offen offset:1024 lds
    v_pk_mul_f32 v[158:159], v[158:159], v[174:175]
    v_pk_mul_f32 v[168:169], v[160:161], v[160:161]
    v_pk_mul_f32 v[170:171], v[162:163], v[162:163]
    v_pk_mul_f32 v[172:173], v[164:165], v[164:165]
    v_pk_mul_f32 v[174:175], v[166:167], v[166:167]
    v_pk_fma_f32 v[168:169], v[168:169], v[20:21], v[20:21] op_sel:[0,1,0] op_sel_hi:[1,1,0]
    v_pk_fma_f32 v[170:171], v[170:171], v[20:21], v[20:21] op_sel:[0,1,0] op_sel_hi:[1,1,0]
    v_pk_fma_f32 v[172:173], v[172:173], v[20:21], v[20:21] op_sel:[0,1,0] op_sel_hi:[1,1,0]
    v_pk_fma_f32 v[174:175], v[174:175], v[20:21], v[20:21] op_sel:[0,1,0] op_sel_hi:[1,1,0]
    v_pk_mul_f32 v[168:169], v[168:169], v[160:161]
    v_pk_mul_f32 v[170:171], v[170:171], v[162:163]
    v_pk_mul_f32 v[172:173], v[172:173], v[164:165]
    s_add_u32 m0, s55, 18432
    s_xor_b32 s74, s62, 256
    buffer_load_dwordx4 v16, s[12:15], s74 offen lds
    v_pk_mul_f32 v[174:175], v[174:175], v[166:167]
    v_exp_f32 v168, v168
    v_exp_f32 v169, v169
    v_exp_f32 v170, v170
    v_exp_f32 v171, v171
    v_exp_f32 v172, v172
    v_exp_f32 v173, v173
    v_exp_f32 v174, v174
    buffer_load_dwordx4 v17, s[12:15], s74 offen offset:1024 lds
    v_exp_f32 v175, v175
    v_pk_add_f32 v[168:169], v[168:169], 1.0 op_sel_hi:[1,0]
    v_pk_add_f32 v[170:171], v[170:171], 1.0 op_sel_hi:[1,0]
    v_pk_add_f32 v[172:173], v[172:173], 1.0 op_sel_hi:[1,0]
    v_pk_add_f32 v[174:175], v[174:175], 1.0 op_sel_hi:[1,0]
    v_rcp_f32 v168, v168
    v_rcp_f32 v169, v169
    v_rcp_f32 v170, v170
    v_rcp_f32 v171, v171
    s_add_u32 m0, s55, 0
    s_xor_b32 s74, s63, 256
    s_waitcnt lgkmcnt(4)
    buffer_load_dwordx4 v16, s[12:15], s74 offen lds
    v_rcp_f32 v172, v172
    v_rcp_f32 v173, v173
    v_rcp_f32 v174, v174
    v_rcp_f32 v175, v175
    v_pk_mul_f32 v[160:161], v[160:161], v[168:169]
    v_pk_mul_f32 v[162:163], v[162:163], v[170:171]
    v_pk_mul_f32 v[164:165], v[164:165], v[172:173]
    v_pk_mul_f32 v[166:167], v[166:167], v[174:175]
    v_pk_add_f32 v[176:177], v[144:145], v[146:147]
    v_pk_mul_f32 v[180:181], v[144:145], v[144:145]
    buffer_load_dwordx4 v17, s[12:15], s74 offen offset:1024 lds
    v_pk_fma_f32 v[180:181], v[146:147], v[146:147], v[180:181]
    v_pk_add_f32 v[176:177], v[176:177], v[148:149]
    v_pk_fma_f32 v[180:181], v[148:149], v[148:149], v[180:181]
    v_pk_add_f32 v[176:177], v[176:177], v[150:151]
    v_pk_fma_f32 v[180:181], v[150:151], v[150:151], v[180:181]
    v_pk_add_f32 v[176:177], v[176:177], v[152:153]
    v_pk_fma_f32 v[180:181], v[152:153], v[152:153], v[180:181]
    v_pk_add_f32 v[176:177], v[176:177], v[154:155]
    v_pk_fma_f32 v[180:181], v[154:155], v[154:155], v[180:181]
    s_waitcnt vmcnt(13)
    ds_read_b128 a[16:19], v18 offset:8192
    ds_read_b128 a[48:51], v19 offset:8192
    v_pk_add_f32 v[176:177], v[176:177], v[156:157]
    ds_read_b128 a[20:23], v18 offset:10240
    ds_read_b128 a[52:55], v19 offset:10240
    s_add_u32 m0, s55, 2048
    s_xor_b32 s74, s64, 256
    buffer_load_dwordx4 v16, s[12:15], s74 offen lds
    v_pk_fma_f32 v[180:181], v[156:157], v[156:157], v[180:181]
    v_pk_add_f32 v[176:177], v[176:177], v[158:159]
    v_pk_fma_f32 v[180:181], v[158:159], v[158:159], v[180:181]
    v_pk_add_f32 v[176:177], v[176:177], v[160:161]
    v_pk_fma_f32 v[180:181], v[160:161], v[160:161], v[180:181]
    v_pk_add_f32 v[176:177], v[176:177], v[162:163]
    v_pk_fma_f32 v[180:181], v[162:163], v[162:163], v[180:181]
    v_pk_add_f32 v[176:177], v[176:177], v[164:165]
    v_pk_fma_f32 v[180:181], v[164:165], v[164:165], v[180:181]
    v_pk_add_f32 v[176:177], v[176:177], v[166:167]
    buffer_load_dwordx4 v17, s[12:15], s74 offen offset:1024 lds
    v_pk_fma_f32 v[180:181], v[166:167], v[166:167], v[180:181]
    v_add_f32 v176, v176, v177
    v_add_f32 v178, v180, v181
    v_mov_b32 v182, v176
    v_mov_b32 v183, v178
    s_nop 0
    v_permlane32_swap_b32 v182, v176
    v_permlane32_swap_b32 v183, v178
    v_add_f32 v176, v176, v182
    v_add_f32 v178, v178, v183
    v_mov_b32 v182, v176
    v_mov_b32 v183, v178
    s_nop 0
    v_permlane16_swap_b32 v182, v176
    v_permlane16_swap_b32 v183, v178
    s_add_u32 m0, s55, 4096
    s_xor_b32 s74, s61, 384
    s_waitcnt lgkmcnt(4)
    buffer_load_dwordx4 v16, s[12:15], s74 offen lds
    v_add_f32 v176, v176, v182
    v_add_f32 v178, v178, v183
    v_mov_b32 v177, s53
    v_mov_b32 v179, s53
    s_lshl_b32 s68, s49, 8
    s_add_u32 s68, s68, s82
    s_mov_b64 exec, 0xffff
    buffer_store_dwordx4 v[176:179], v2, s[28:31], s68 offen sc1
    s_mov_b64 exec, -1
    s_barrier
    ds_read_b128 a[200:203], v25 offset:0
    ds_read_b128 a[232:235], v25 offset:6144
    buffer_load_dwordx4 v17, s[12:15], s74 offen offset:1024 lds
    ds_read_b128 a[204:207], v25 offset:12288
    ds_read_b128 a[236:239], v25 offset:16384
    ds_read_b128 a[208:211], v25 offset:22528
    ds_read_b128 a[240:243], v25 offset:28672
    ds_read_b128 v[172:175], v36 offset:0
    ds_read_b128 v[176:179], v37 offset:640
    s_waitcnt lgkmcnt(0)
    v_mfma_f32_16x16x32_bf16 v[192:195], v[64:67], a[200:203], 0
    ds_read_b128 a[212:215], v28 offset:0
    s_nop 0
    v_mfma_f32_16x16x32_bf16 v[196:199], v[64:67], a[232:235], 0
    ds_read_b128 a[244:247], v28 offset:6144
    s_add_u32 m0, s55, 6144
    s_xor_b32 s74, s62, 384
    buffer_load_dwordx4 v16, s[12:15], s74 offen lds
    v_mfma_f32_16x16x32_bf16 v[200:203], v[64:67], a[204:207], 0
    ds_read_b128 a[216:219], v28 offset:12288
    v_mfma_f32_16x16x32_bf16 v[204:207], v[64:67], a[236:239], 0
    ds_read_b128 a[248:251], v28 offset:16384
    v_mfma_f32_16x16x32_bf16 v[208:211], v[64:67], a[208:211], 0
    ds_read_b128 a[220:223], v28 offset:22528
    v_mfma_f32_16x16x32_bf16 v[212:215], v[64:67], a[240:243], 0
    ds_read_b128 a[252:255], v28 offset:28672
    buffer_load_dwordx4 v17, s[12:15], s74 offen offset:1024 lds
    v_mfma_f32_16x16x32_bf16 v[168:171], v[172:175], v[64:67], 0
    v_mfma_f32_16x16x32_bf16 v[216:219], v[104:107], a[200:203], 0
    ds_read_b128 v[180:183], v36 offset:64
    v_mfma_f32_16x16x32_bf16 v[220:223], v[104:107], a[232:235], 0
    ds_read_b128 v[184:187], v37 offset:704
    v_mfma_f32_16x16x32_bf16 v[224:227], v[104:107], a[204:207], 0
    v_mfma_f32_16x16x32_bf16 v[228:231], v[104:107], a[236:239], 0
    s_add_u32 m0, s55, 8192
    s_xor_b32 s74, s63, 384
    buffer_load_dwordx4 v16, s[12:15], s74 offen lds
    v_mfma_f32_16x16x32_bf16 v[232:235], v[104:107], a[208:211], 0
    v_mfma_f32_16x16x32_bf16 v[236:239], v[104:107], a[240:243], 0
    v_mfma_f32_16x16x32_bf16 v[168:171], v[176:179], v[104:107], v[168:171]
    s_waitcnt lgkmcnt(0)
    v_mfma_f32_16x16x32_bf16 v[192:195], v[68:71], a[212:215], v[192:195]
    buffer_load_dwordx4 v17, s[12:15], s74 offen offset:1024 lds
    ds_read_b128 a[200:203], v25 offset:128
    v_mfma_f32_16x16x32_bf16 v[196:199], v[68:71], a[244:247], v[196:199]
    ds_read_b128 a[232:235], v25 offset:6272
    s_waitcnt vmcnt(15)
    ds_read_b128 a[24:27], v18 offset:12288
    ds_read_b128 a[56:59], v19 offset:12288
    v_mfma_f32_16x16x32_bf16 v[200:203], v[68:71], a[216:219], v[200:203]
    ds_read_b128 a[28:31], v18 offset:14336
    ds_read_b128 a[60:63], v19 offset:14336
    ds_read_b128 a[204:207], v25 offset:12416
    v_mfma_f32_16x16x32_bf16 v[204:207], v[68:71], a[248:251], v[204:207]
    s_add_u32 m0, s55, 10240
    s_xor_b32 s74, s64, 384
    buffer_load_dwordx4 v16, s[12:15], s74 offen lds
    ds_read_b128 a[236:239], v25 offset:16512
    v_mfma_f32_16x16x32_bf16 v[208:211], v[68:71], a[220:223], v[208:211]
    ds_read_b128 a[208:211], v25 offset:22656
    v_mfma_f32_16x16x32_bf16 v[212:215], v[68:71], a[252:255], v[212:215]
    ds_read_b128 a[240:243], v25 offset:28800
    v_mfma_f32_16x16x32_bf16 v[168:171], v[180:183], v[68:71], v[168:171]
    v_mfma_f32_16x16x32_bf16 v[216:219], v[108:111], a[212:215], v[216:219]
    buffer_load_dwordx4 v17, s[12:15], s74 offen offset:1024 lds
    ds_read_b128 v[172:175], v36 offset:128
    v_mfma_f32_16x16x32_bf16 v[220:223], v[108:111], a[244:247], v[220:223]
    ds_read_b128 v[176:179], v37 offset:768
    v_mfma_f32_16x16x32_bf16 v[224:227], v[108:111], a[216:219], v[224:227]
    v_mfma_f32_16x16x32_bf16 v[228:231], v[108:111], a[248:251], v[228:231]
    v_mfma_f32_16x16x32_bf16 v[232:235], v[108:111], a[220:223], v[232:235]
    s_add_u32 m0, s55, 12288
    s_xor_b32 s74, s61, 512
    s_waitcnt lgkmcnt(6)
    buffer_load_dwordx4 v16, s[12:15], s74 offen lds
    v_mfma_f32_16x16x32_bf16 v[236:239], v[108:111], a[252:255], v[236:239]
    v_mfma_f32_16x16x32_bf16 v[168:171], v[184:187], v[108:111], v[168:171]
    v_mfma_f32_16x16x32_bf16 v[192:195], v[72:75], a[200:203], v[192:195]
    ds_read_b128 a[212:215], v28 offset:128
    v_mfma_f32_16x16x32_bf16 v[196:199], v[72:75], a[232:235], v[196:199]
    buffer_load_dwordx4 v17, s[12:15], s74 offen offset:1024 lds
    ds_read_b128 a[244:247], v28 offset:6272
    s_waitcnt lgkmcnt(7)
    v_mfma_f32_16x16x32_bf16 v[200:203], v[72:75], a[204:207], v[200:203]
    ds_read_b128 a[216:219], v28 offset:12416
    s_waitcnt lgkmcnt(7)
    v_mfma_f32_16x16x32_bf16 v[204:207], v[72:75], a[236:239], v[204:207]
    s_waitcnt vmcnt(15)
    ds_read_b128 a[64:67], v18 offset:16384
    ds_read_b128 a[96:99], v19 offset:16384
    ds_read_b128 a[248:251], v28 offset:16512
    ds_read_b128 a[68:71], v18 offset:18432
    ds_read_b128 a[100:103], v19 offset:18432
    s_waitcnt lgkmcnt(11)
    v_mfma_f32_16x16x32_bf16 v[208:211], v[72:75], a[208:211], v[208:211]
    s_add_u32 m0, s55, 14336
    s_xor_b32 s74, s62, 512
    buffer_load_dwordx4 v16, s[12:15], s74 offen lds
    ds_read_b128 a[220:223], v28 offset:22656
    s_waitcnt lgkmcnt(11)
    v_mfma_f32_16x16x32_bf16 v[212:215], v[72:75], a[240:243], v[212:215]
    ds_read_b128 a[252:255], v28 offset:28800
    s_waitcnt lgkmcnt(11)
    v_mfma_f32_16x16x32_bf16 v[168:171], v[172:175], v[72:75], v[168:171]
    v_mfma_f32_16x16x32_bf16 v[216:219], v[112:115], a[200:203], v[216:219]
    ds_read_b128 v[180:183], v36 offset:192
    v_mfma_f32_16x16x32_bf16 v[220:223], v[112:115], a[232:235], v[220:223]
    buffer_load_dwordx4 v17, s[12:15], s74 offen offset:1024 lds
    ds_read_b128 v[184:187], v37 offset:832
    v_mfma_f32_16x16x32_bf16 v[224:227], v[112:115], a[204:207], v[224:227]
    v_mfma_f32_16x16x32_bf16 v[228:231], v[112:115], a[236:239], v[228:231]
    v_mfma_f32_16x16x32_bf16 v[232:235], v[112:115], a[208:211], v[232:235]
    v_mfma_f32_16x16x32_bf16 v[236:239], v[112:115], a[240:243], v[236:239]
    s_add_u32 m0, s55, 16384
    s_xor_b32 s74, s63, 512
    s_waitcnt lgkmcnt(4)
    buffer_load_dwordx4 v16, s[12:15], s74 offen lds
    v_mfma_f32_16x16x32_bf16 v[168:171], v[176:179], v[112:115], v[168:171]
    s_mul_i32 s68, s49, 122880
    s_mul_i32 s69, s48, 5120
    s_add_u32 s68, s68, s69
    s_add_u32 s68, s68, 16777216
    s_cmp_ge_u32 s48, 24
    s_cselect_b32 s68, 0x10000000, s68
    s_lshl_b32 s69, s50, 10
    s_add_u32 s69, s69, s68
    s_add_u32 s68, s68, 4096
    s_lshl_b32 s70, s50, 4
    buffer_store_dwordx4 v[248:251], v2, s[28:31], s69 offen sc1
    s_mov_b64 exec, 0xffff
    s_lshl_b64 exec, exec, s70
    buffer_store_dwordx4 v[252:255], v2, s[28:31], s68 offen sc1
    s_mov_b64 exec, -1
    buffer_load_dwordx4 v17, s[12:15], s74 offen offset:1024 lds
    v_mfma_f32_16x16x32_bf16 v[192:195], v[76:79], a[212:215], v[192:195]
    s_waitcnt vmcnt(17)
    ds_read_b128 a[72:75], v18 offset:0
    ds_read_b128 a[104:107], v19 offset:0
    ds_read_b128 a[200:203], v25 offset:256
    ds_read_b128 a[76:79], v18 offset:2048
    ds_read_b128 a[108:111], v19 offset:2048
    v_mfma_f32_16x16x32_bf16 v[196:199], v[76:79], a[244:247], v[196:199]
    s_add_u32 m0, s55, 18432
    s_xor_b32 s74, s64, 512
    buffer_load_dwordx4 v16, s[12:15], s74 offen lds
    ds_read_b128 a[232:235], v25 offset:6400
    v_mfma_f32_16x16x32_bf16 v[200:203], v[76:79], a[216:219], v[200:203]
    ds_read_b128 a[204:207], v25 offset:12544
    v_mfma_f32_16x16x32_bf16 v[204:207], v[76:79], a[248:251], v[204:207]
    ds_read_b128 a[236:239], v25 offset:16640
    s_waitcnt lgkmcnt(11)
    v_mfma_f32_16x16x32_bf16 v[208:211], v[76:79], a[220:223], v[208:211]
    ds_read_b128 a[208:211], v25 offset:22784
    s_waitcnt lgkmcnt(11)
    v_mfma_f32_16x16x32_bf16 v[212:215], v[76:79], a[252:255], v[212:215]
    buffer_load_dwordx4 v17, s[12:15], s74 offen offset:1024 lds
    ds_read_b128 a[240:243], v25 offset:28928
    s_waitcnt lgkmcnt(11)
    v_mfma_f32_16x16x32_bf16 v[168:171], v[180:183], v[76:79], v[168:171]
    v_mfma_f32_16x16x32_bf16 v[216:219], v[116:119], a[212:215], v[216:219]
    ds_read_b128 v[172:175], v36 offset:256
    v_mfma_f32_16x16x32_bf16 v[220:223], v[116:119], a[244:247], v[220:223]
    ds_read_b128 v[176:179], v37 offset:896
    v_mfma_f32_16x16x32_bf16 v[224:227], v[116:119], a[216:219], v[224:227]
    s_add_u32 m0, s55, 0
    s_xor_b32 s74, s61, 640
    s_waitcnt lgkmcnt(7)
    buffer_load_dwordx4 v16, s[12:15], s74 offen lds
    v_mfma_f32_16x16x32_bf16 v[228:231], v[116:119], a[248:251], v[228:231]
    v_mfma_f32_16x16x32_bf16 v[232:235], v[116:119], a[220:223], v[232:235]
    v_mfma_f32_16x16x32_bf16 v[236:239], v[116:119], a[252:255], v[236:239]
    v_mfma_f32_16x16x32_bf16 v[168:171], v[184:187], v[116:119], v[168:171]
    v_mfma_f32_16x16x32_bf16 v[192:195], v[80:83], a[200:203], v[192:195]
    buffer_load_dwordx4 v17, s[12:15], s74 offen offset:1024 lds
    ds_read_b128 a[212:215], v26 offset:0
    s_waitcnt lgkmcnt(7)
    v_mfma_f32_16x16x32_bf16 v[196:199], v[80:83], a[232:235], v[196:199]
    s_waitcnt vmcnt(16)
    ds_read_b128 a[80:83], v18 offset:4096
    ds_read_b128 a[112:115], v19 offset:4096
    ds_read_b128 a[244:247], v26 offset:6144
    ds_read_b128 a[84:87], v18 offset:6144
    ds_read_b128 a[116:119], v19 offset:6144
    s_waitcnt lgkmcnt(11)
    v_mfma_f32_16x16x32_bf16 v[200:203], v[80:83], a[204:207], v[200:203]
    s_add_u32 m0, s55, 2048
    s_xor_b32 s74, s62, 640
    buffer_load_dwordx4 v16, s[12:15], s74 offen lds
    ds_read_b128 a[216:219], v26 offset:12288
    s_waitcnt lgkmcnt(11)
    v_mfma_f32_16x16x32_bf16 v[204:207], v[80:83], a[236:239], v[204:207]
    ds_read_b128 a[248:251], v27 offset:0
    s_waitcnt lgkmcnt(11)
    v_mfma_f32_16x16x32_bf16 v[208:211], v[80:83], a[208:211], v[208:211]
    ds_read_b128 a[220:223], v27 offset:6144
    s_waitcnt lgkmcnt(11)
    v_mfma_f32_16x16x32_bf16 v[212:215], v[80:83], a[240:243], v[212:215]
    ds_read_b128 a[252:255], v27 offset:12288
    s_waitcnt lgkmcnt(11)
    v_mfma_f32_16x16x32_bf16 v[168:171], v[172:175], v[80:83], v[168:171]
    buffer_load_dwordx4 v17, s[12:15], s74 offen offset:1024 lds
    v_mfma_f32_16x16x32_bf16 v[216:219], v[120:123], a[200:203], v[216:219]
    ds_read_b128 v[180:183], v36 offset:320
    v_mfma_f32_16x16x32_bf16 v[220:223], v[120:123], a[232:235], v[220:223]
    ds_read_b128 v[184:187], v37 offset:960
    v_mfma_f32_16x16x32_bf16 v[224:227], v[120:123], a[204:207], v[224:227]
    v_mfma_f32_16x16x32_bf16 v[228:231], v[120:123], a[236:239], v[228:231]
    v_mfma_f32_16x16x32_bf16 v[232:235], v[120:123], a[208:211], v[232:235]
    s_add_u32 m0, s55, 4096
    s_xor_b32 s74, s63, 640
    s_waitcnt lgkmcnt(6)
    buffer_load_dwordx4 v16, s[12:15], s74 offen lds
    v_mfma_f32_16x16x32_bf16 v[236:239], v[120:123], a[240:243], v[236:239]
    v_mfma_f32_16x16x32_bf16 v[168:171], v[176:179], v[120:123], v[168:171]
    v_pk_mul_f32 v[192:193], v[192:193], v[32:33] op_sel:[0,0] op_sel_hi:[1,0]
    v_pk_mul_f32 v[194:195], v[194:195], v[32:33] op_sel:[0,0] op_sel_hi:[1,0]
    v_pk_mul_f32 v[196:197], v[196:197], v[32:33] op_sel:[0,0] op_sel_hi:[1,0]
    v_pk_mul_f32 v[198:199], v[198:199], v[32:33] op_sel:[0,0] op_sel_hi:[1,0]
    v_pk_mul_f32 v[200:201], v[200:201], v[32:33] op_sel:[0,0] op_sel_hi:[1,0]
    v_pk_mul_f32 v[202:203], v[202:203], v[32:33] op_sel:[0,0] op_sel_hi:[1,0]
    buffer_load_dwordx4 v17, s[12:15], s74 offen offset:1024 lds
    v_pk_mul_f32 v[204:205], v[204:205], v[32:33] op_sel:[0,1] op_sel_hi:[1,1]
    v_pk_mul_f32 v[206:207], v[206:207], v[32:33] op_sel:[0,1] op_sel_hi:[1,1]
    v_pk_mul_f32 v[208:209], v[208:209], v[32:33] op_sel:[0,1] op_sel_hi:[1,1]
    v_pk_mul_f32 v[210:211], v[210:211], v[32:33] op_sel:[0,1] op_sel_hi:[1,1]
    v_pk_mul_f32 v[212:213], v[212:213], v[32:33] op_sel:[0,1] op_sel_hi:[1,1]
    s_waitcnt vmcnt(16)
    ds_read_b128 a[88:91], v18 offset:8192
    ds_read_b128 a[120:123], v19 offset:8192
    v_pk_mul_f32 v[214:215], v[214:215], v[32:33] op_sel:[0,1] op_sel_hi:[1,1]
    ds_read_b128 a[92:95], v18 offset:10240
    ds_read_b128 a[124:127], v19 offset:10240
    v_pk_mul_f32 v[216:217], v[216:217], v[32:33] op_sel:[0,0] op_sel_hi:[1,0]
    v_pk_mul_f32 v[218:219], v[218:219], v[32:33] op_sel:[0,0] op_sel_hi:[1,0]
    s_add_u32 m0, s55, 6144
    s_xor_b32 s74, s64, 640
    buffer_load_dwordx4 v16, s[12:15], s74 offen lds
    v_pk_mul_f32 v[220:221], v[220:221], v[32:33] op_sel:[0,0] op_sel_hi:[1,0]
    v_pk_mul_f32 v[222:223], v[222:223], v[32:33] op_sel:[0,0] op_sel_hi:[1,0]
    v_pk_mul_f32 v[224:225], v[224:225], v[32:33] op_sel:[0,0] op_sel_hi:[1,0]
    v_pk_mul_f32 v[226:227], v[226:227], v[32:33] op_sel:[0,0] op_sel_hi:[1,0]
    v_pk_mul_f32 v[228:229], v[228:229], v[32:33] op_sel:[0,1] op_sel_hi:[1,1]
    v_pk_mul_f32 v[230:231], v[230:231], v[32:33] op_sel:[0,1] op_sel_hi:[1,1]
    v_pk_mul_f32 v[232:233], v[232:233], v[32:33] op_sel:[0,1] op_sel_hi:[1,1]
    v_pk_mul_f32 v[234:235], v[234:235], v[32:33] op_sel:[0,1] op_sel_hi:[1,1]
    v_pk_mul_f32 v[236:237], v[236:237], v[32:33] op_sel:[0,1] op_sel_hi:[1,1]
    v_pk_mul_f32 v[238:239], v[238:239], v[32:33] op_sel:[0,1] op_sel_hi:[1,1]
    s_nop 0
    v_mfma_f32_16x16x32_bf16 v[192:195], v[84:87], a[212:215], v[192:195]
    buffer_load_dwordx4 v17, s[12:15], s74 offen offset:1024 lds
    ds_read_b128 a[200:203], v29 offset:0
    v_mfma_f32_16x16x32_bf16 v[196:199], v[84:87], a[244:247], v[196:199]
    ds_read_b128 a[232:235], v29 offset:6144
    s_waitcnt lgkmcnt(11)
    v_mfma_f32_16x16x32_bf16 v[200:203], v[84:87], a[216:219], v[200:203]
    ds_read_b128 a[204:207], v29 offset:12288
    s_waitcnt lgkmcnt(11)
    v_mfma_f32_16x16x32_bf16 v[204:207], v[84:87], a[248:251], v[204:207]
    ds_read_b128 a[236:239], v30 offset:0
    s_waitcnt lgkmcnt(11)
    v_mfma_f32_16x16x32_bf16 v[208:211], v[84:87], a[220:223], v[208:211]
    s_add_u32 m0, s55, 8192
    s_xor_b32 s74, s61, 768
    s_waitcnt lgkmcnt(4)
    buffer_load_dwordx4 v16, s[12:15], s74 offen lds
    ds_read_b128 a[208:211], v30 offset:6144
    v_mfma_f32_16x16x32_bf16 v[212:215], v[84:87], a[252:255], v[212:215]
    ds_read_b128 a[240:243], v30 offset:12288
    v_mfma_f32_16x16x32_bf16 v[168:171], v[180:183], v[84:87], v[168:171]
    v_mfma_f32_16x16x32_bf16 v[216:219], v[124:127], a[212:215], v[216:219]
    ds_read_b128 v[172:175], v36 offset:384
    v_mfma_f32_16x16x32_bf16 v[220:223], v[124:127], a[244:247], v[220:223]
    buffer_load_dwordx4 v17, s[12:15], s74 offen offset:1024 lds
    ds_read_b128 v[176:179], v37 offset:1024
    v_mfma_f32_16x16x32_bf16 v[224:227], v[124:127], a[216:219], v[224:227]
    v_mfma_f32_16x16x32_bf16 v[228:231], v[124:127], a[248:251], v[228:231]
    s_waitcnt vmcnt(16)
    ds_read_b128 a[128:131], v18 offset:12288
    ds_read_b128 a[160:163], v19 offset:12288
    v_mfma_f32_16x16x32_bf16 v[232:235], v[124:127], a[220:223], v[232:235]
    ds_read_b128 a[132:135], v18 offset:14336
    ds_read_b128 a[164:167], v19 offset:14336
    v_mfma_f32_16x16x32_bf16 v[236:239], v[124:127], a[252:255], v[236:239]
    s_add_u32 m0, s55, 10240
    s_xor_b32 s74, s62, 768
    buffer_load_dwordx4 v16, s[12:15], s74 offen lds
    v_mfma_f32_16x16x32_bf16 v[168:171], v[184:187], v[124:127], v[168:171]
    s_waitcnt lgkmcnt(0)
    v_mfma_f32_16x16x32_bf16 v[192:195], v[88:91], a[200:203], v[192:195]
    ds_read_b128 a[212:215], v26 offset:128
    v_mfma_f32_16x16x32_bf16 v[196:199], v[88:91], a[232:235], v[196:199]
    ds_read_b128 a[244:247], v26 offset:6272
    v_mfma_f32_16x16x32_bf16 v[200:203], v[88:91], a[204:207], v[200:203]
    ds_read_b128 a[216:219], v26 offset:12416
    buffer_load_dwordx4 v17, s[12:15], s74 offen offset:1024 lds
    v_mfma_f32_16x16x32_bf16 v[204:207], v[88:91], a[236:239], v[204:207]
    ds_read_b128 a[248:251], v27 offset:128
    v_mfma_f32_16x16x32_bf16 v[208:211], v[88:91], a[208:211], v[208:211]
    ds_read_b128 a[220:223], v27 offset:6272
    v_mfma_f32_16x16x32_bf16 v[212:215], v[88:91], a[240:243], v[212:215]
    ds_read_b128 a[252:255], v27 offset:12416
    v_mfma_f32_16x16x32_bf16 v[168:171], v[172:175], v[88:91], v[168:171]
    v_mfma_f32_16x16x32_bf16 v[216:219], v[128:131], a[200:203], v[216:219]
    s_add_u32 m0, s55, 12288
    s_xor_b32 s74, s63, 768
    buffer_load_dwordx4 v16, s[12:15], s74 offen lds
    ds_read_b128 v[180:183], v36 offset:448
    v_mfma_f32_16x16x32_bf16 v[220:223], v[128:131], a[232:235], v[220:223]
    ds_read_b128 v[184:187], v37 offset:1088
    v_mfma_f32_16x16x32_bf16 v[224:227], v[128:131], a[204:207], v[224:227]
    v_mfma_f32_16x16x32_bf16 v[228:231], v[128:131], a[236:239], v[228:231]
    v_mfma_f32_16x16x32_bf16 v[232:235], v[128:131], a[208:211], v[232:235]
    buffer_load_dwordx4 v17, s[12:15], s74 offen offset:1024 lds
    v_mfma_f32_16x16x32_bf16 v[236:239], v[128:131], a[240:243], v[236:239]
    v_mfma_f32_16x16x32_bf16 v[168:171], v[176:179], v[128:131], v[168:171]
    s_waitcnt vmcnt(14)
    ds_read_b128 a[136:139], v18 offset:16384
    ds_read_b128 a[168:171], v19 offset:16384
    buffer_load_dwordx4 v[240:243], v2, s[28:31], s82 offen offset:0 sc1
    ds_read_b128 a[140:143], v18 offset:18432
    ds_read_b128 a[172:175], v19 offset:18432
    s_add_u32 m0, s55, 14336
    s_xor_b32 s74, s64, 768
    buffer_load_dwordx4 v16, s[12:15], s74 offen lds
    buffer_load_dwordx4 v[244:247], v2, s[28:31], s82 offen offset:1024 sc1
    s_waitcnt lgkmcnt(0)
    v_mfma_f32_16x16x32_bf16 v[192:195], v[92:95], a[212:215], v[192:195]
    ds_read_b128 a[200:203], v29 offset:128
    v_mfma_f32_16x16x32_bf16 v[196:199], v[92:95], a[244:247], v[196:199]
    ds_read_b128 a[232:235], v29 offset:6272
    v_mfma_f32_16x16x32_bf16 v[200:203], v[92:95], a[216:219], v[200:203]
    ds_read_b128 a[204:207], v29 offset:12416
    v_mfma_f32_16x16x32_bf16 v[204:207], v[92:95], a[248:251], v[204:207]
    buffer_load_dwordx4 v17, s[12:15], s74 offen offset:1024 lds
    ds_read_b128 a[236:239], v30 offset:128
    v_mfma_f32_16x16x32_bf16 v[208:211], v[92:95], a[220:223], v[208:211]
    ds_read_b128 a[208:211], v30 offset:6272
    v_mfma_f32_16x16x32_bf16 v[212:215], v[92:95], a[252:255], v[212:215]
    ds_read_b128 a[240:243], v30 offset:12416
    v_mfma_f32_16x16x32_bf16 v[168:171], v[180:183], v[92:95], v[168:171]
    v_mfma_f32_16x16x32_bf16 v[216:219], v[132:135], a[212:215], v[216:219]
    s_add_u32 m0, s55, 16384
    s_xor_b32 s74, s61, 896
    buffer_load_dwordx4 v16, s[12:15], s74 offen lds
    ds_read_b128 v[172:175], v36 offset:512
    v_mfma_f32_16x16x32_bf16 v[220:223], v[132:135], a[244:247], v[220:223]
    ds_read_b128 v[176:179], v37 offset:1152
    v_mfma_f32_16x16x32_bf16 v[224:227], v[132:135], a[216:219], v[224:227]
    v_mfma_f32_16x16x32_bf16 v[228:231], v[132:135], a[248:251], v[228:231]
    v_mfma_f32_16x16x32_bf16 v[232:235], v[132:135], a[220:223], v[232:235]
    buffer_load_dwordx4 v17, s[12:15], s74 offen offset:1024 lds
    v_mfma_f32_16x16x32_bf16 v[236:239], v[132:135], a[252:255], v[236:239]
    v_mfma_f32_16x16x32_bf16 v[168:171], v[184:187], v[132:135], v[168:171]
    s_waitcnt vmcnt(16)
    ds_read_b128 a[144:147], v18 offset:0
    ds_read_b128 a[176:179], v19 offset:0
    s_waitcnt lgkmcnt(0)
    v_mfma_f32_16x16x32_bf16 v[192:195], v[96:99], a[200:203], v[192:195]
    ds_read_b128 a[148:151], v18 offset:2048
    ds_read_b128 a[180:183], v19 offset:2048
    ds_read_b128 a[212:215], v26 offset:256
    v_mfma_f32_16x16x32_bf16 v[196:199], v[96:99], a[232:235], v[196:199]
    s_add_u32 m0, s55, 18432
    s_xor_b32 s74, s62, 896
    buffer_load_dwordx4 v16, s[12:15], s74 offen lds
    ds_read_b128 a[244:247], v26 offset:6400
    v_mfma_f32_16x16x32_bf16 v[200:203], v[96:99], a[204:207], v[200:203]
    ds_read_b128 a[216:219], v26 offset:12544
    v_mfma_f32_16x16x32_bf16 v[204:207], v[96:99], a[236:239], v[204:207]
    ds_read_b128 a[248:251], v27 offset:256
    v_mfma_f32_16x16x32_bf16 v[208:211], v[96:99], a[208:211], v[208:211]
    ds_read_b128 a[220:223], v27 offset:6400
    v_mfma_f32_16x16x32_bf16 v[212:215], v[96:99], a[240:243], v[212:215]
    buffer_load_dwordx4 v17, s[12:15], s74 offen offset:1024 lds
    ds_read_b128 a[252:255], v27 offset:12544
    v_mfma_f32_16x16x32_bf16 v[168:171], v[172:175], v[96:99], v[168:171]
    v_mfma_f32_16x16x32_bf16 v[216:219], v[136:139], a[200:203], v[216:219]
    ds_read_b128 v[180:183], v36 offset:576
    v_mfma_f32_16x16x32_bf16 v[220:223], v[136:139], a[232:235], v[220:223]
    ds_read_b128 v[184:187], v37 offset:1216
    v_mfma_f32_16x16x32_bf16 v[224:227], v[136:139], a[204:207], v[224:227]
    s_add_u32 m0, s55, 0
    s_xor_b32 s74, s63, 896
    s_waitcnt lgkmcnt(8)
    buffer_load_dwordx4 v16, s[12:15], s74 offen lds
    v_mfma_f32_16x16x32_bf16 v[228:231], v[136:139], a[236:239], v[228:231]
    v_mfma_f32_16x16x32_bf16 v[232:235], v[136:139], a[208:211], v[232:235]
    v_mfma_f32_16x16x32_bf16 v[236:239], v[136:139], a[240:243], v[236:239]
    v_mfma_f32_16x16x32_bf16 v[168:171], v[176:179], v[136:139], v[168:171]
    buffer_load_dwordx4 v17, s[12:15], s74 offen offset:1024 lds
    s_waitcnt lgkmcnt(0)
    v_mfma_f32_16x16x32_bf16 v[192:195], v[100:103], a[212:215], v[192:195]
    v_mfma_f32_16x16x32_bf16 v[196:199], v[100:103], a[244:247], v[196:199]
    s_waitcnt vmcnt(16)
    ds_read_b128 a[152:155], v18 offset:4096
    ds_read_b128 a[184:187], v19 offset:4096
    v_mfma_f32_16x16x32_bf16 v[200:203], v[100:103], a[216:219], v[200:203]
    ds_read_b128 a[156:159], v18 offset:6144
    ds_read_b128 a[188:191], v19 offset:6144
    v_mfma_f32_16x16x32_bf16 v[204:207], v[100:103], a[248:251], v[204:207]
    s_add_u32 m0, s55, 2048
    s_xor_b32 s74, s64, 896
    buffer_load_dwordx4 v16, s[12:15], s74 offen lds
    v_mfma_f32_16x16x32_bf16 v[208:211], v[100:103], a[220:223], v[208:211]
    v_mfma_f32_16x16x32_bf16 v[212:215], v[100:103], a[252:255], v[212:215]
    v_mfma_f32_16x16x32_bf16 v[168:171], v[180:183], v[100:103], v[168:171]
    v_mfma_f32_16x16x32_bf16 v[216:219], v[140:143], a[212:215], v[216:219]
    v_mfma_f32_16x16x32_bf16 v[220:223], v[140:143], a[244:247], v[220:223]
    buffer_load_dwordx4 v17, s[12:15], s74 offen offset:1024 lds
    v_mfma_f32_16x16x32_bf16 v[224:227], v[140:143], a[216:219], v[224:227]
    v_mfma_f32_16x16x32_bf16 v[228:231], v[140:143], a[248:251], v[228:231]
    v_mfma_f32_16x16x32_bf16 v[232:235], v[140:143], a[220:223], v[232:235]
    v_mfma_f32_16x16x32_bf16 v[236:239], v[140:143], a[252:255], v[236:239]
    v_mfma_f32_16x16x32_bf16 v[168:171], v[184:187], v[140:143], v[168:171]
    s_waitcnt vmcnt(9)
    v_xor_b32 v42, s53, v241
    v_xor_b32 v43, s53, v243
    v_or_b32 v42, v42, v43
    v_xor_b32 v43, s53, v245
    v_or_b32 v42, v42, v43
    v_xor_b32 v43, s53, v247
    v_or_b32 v42, v42, v43
    v_cmp_ne_u32 vcc, 0, v42
    s_nop 0
    s_cbranch_vccnz L_slow0
L_back0:
    v_add_f32 v240, v240, v244
    v_add_f32 v242, v242, v246
    v_mov_b32 v42, v240
    v_mov_b32 v43, v242
    s_nop 0
    v_permlane32_swap_b32 v42, v240
    v_permlane32_swap_b32 v43, v242
    v_add_f32 v240, v240, v42
    v_add_f32 v242, v242, v43
    v_mov_b32 v42, v240
    v_mov_b32 v43, v242
    s_nop 0
    v_permlane16_swap_b32 v42, v240
    v_permlane16_swap_b32 v43, v242
    v_add_f32 v240, v240, v42
    v_add_f32 v242, v242, v43
    v_mul_f32 v240, 0x3aaaaaab, v240
    v_mul_f32 v242, 0x3aaaaaab, v242
    v_fma_f32 v242, -v240, v240, v242
    v_max_f32 v242, 0, v242
    v_add_f32 v242, 0x3727c5ac, v242
    v_rsq_f32 v242, v242
    s_nop 0
    v_mul_f32 v243, v240, v242
    v_pk_fma_f32 v[144:145], v[144:145], v[242:243], v[242:243] op_sel:[0,0,1] op_sel_hi:[1,0,1] neg_lo:[0,0,1] neg_hi:[0,0,1]
    v_pk_fma_f32 v[146:147], v[146:147], v[242:243], v[242:243] op_sel:[0,0,1] op_sel_hi:[1,0,1] neg_lo:[0,0,1] neg_hi:[0,0,1]
    v_pk_fma_f32 v[148:149], v[148:149], v[242:243], v[242:243] op_sel:[0,0,1] op_sel_hi:[1,0,1] neg_lo:[0,0,1] neg_hi:[0,0,1]
    v_pk_fma_f32 v[150:151], v[150:151], v[242:243], v[242:243] op_sel:[0,0,1] op_sel_hi:[1,0,1] neg_lo:[0,0,1] neg_hi:[0,0,1]
    v_pk_fma_f32 v[152:153], v[152:153], v[242:243], v[242:243] op_sel:[0,0,1] op_sel_hi:[1,0,1] neg_lo:[0,0,1] neg_hi:[0,0,1]
    v_pk_fma_f32 v[154:155], v[154:155], v[242:243], v[242:243] op_sel:[0,0,1] op_sel_hi:[1,0,1] neg_lo:[0,0,1] neg_hi:[0,0,1]
    v_pk_fma_f32 v[156:157], v[156:157], v[242:243], v[242:243] op_sel:[0,0,1] op_sel_hi:[1,0,1] neg_lo:[0,0,1] neg_hi:[0,0,1]
    v_pk_fma_f32 v[158:159], v[158:159], v[242:243], v[242:243] op_sel:[0,0,1] op_sel_hi:[1,0,1] neg_lo:[0,0,1] neg_hi:[0,0,1]
    v_pk_fma_f32 v[160:161], v[160:161], v[242:243], v[242:243] op_sel:[0,0,1] op_sel_hi:[1,0,1] neg_lo:[0,0,1] neg_hi:[0,0,1]
    v_pk_fma_f32 v[162:163], v[162:163], v[242:243], v[242:243] op_sel:[0,0,1] op_sel_hi:[1,0,1] neg_lo:[0,0,1] neg_hi:[0,0,1]
    v_pk_fma_f32 v[164:165], v[164:165], v[242:243], v[242:243] op_sel:[0,0,1] op_sel_hi:[1,0,1] neg_lo:[0,0,1] neg_hi:[0,0,1]
    v_pk_fma_f32 v[166:167], v[166:167], v[242:243], v[242:243] op_sel:[0,0,1] op_sel_hi:[1,0,1] neg_lo:[0,0,1] neg_hi:[0,0,1]
    v_cvt_pk_bf16_f32 v244, v144, v145
    v_cvt_pk_bf16_f32 v245, v146, v147
    v_cvt_pk_bf16_f32 v246, v148, v149
    v_cvt_pk_bf16_f32 v247, v150, v151
    v_cvt_pk_bf16_f32 v248, v152, v153
    v_cvt_pk_bf16_f32 v249, v154, v155
    v_cvt_pk_bf16_f32 v250, v156, v157
    v_cvt_pk_bf16_f32 v251, v158, v159
    v_cvt_pk_bf16_f32 v252, v160, v161
    v_cvt_pk_bf16_f32 v253, v162, v163
    v_cvt_pk_bf16_f32 v254, v164, v165
    v_cvt_pk_bf16_f32 v255, v166, v167
    s_bitcmp1_b32 s48, 3
    s_cselect_b64 exec, -1, 0
    v_swap_b32 v244, v246
    v_swap_b32 v245, v247
    v_swap_b32 v248, v250
    v_swap_b32 v249, v251
    v_swap_b32 v252, v254
    v_swap_b32 v253, v255
    s_mov_b64 exec, -1
    s_add_u32 s68, s66, 0
    buffer_store_dwordx4 v[244:247], v24, s[28:31], s68 offen sc1
    s_add_u32 s68, s66, 131072
    buffer_store_dwordx4 v[248:251], v24, s[28:31], s68 offen sc1
    s_add_u32 s68, s66, 262144
    buffer_store_dwordx4 v[252:255], v24, s[28:31], s68 offen sc1
    v_pk_fma_f32 v[192:193], v[216:217], v[34:35], v[192:193] op_sel_hi:[1,0,1]
    v_pk_fma_f32 v[194:195], v[218:219], v[34:35], v[194:195] op_sel_hi:[1,0,1]
    v_pk_fma_f32 v[196:197], v[220:221], v[34:35], v[196:197] op_sel_hi:[1,0,1]
    v_pk_fma_f32 v[198:199], v[222:223], v[34:35], v[198:199] op_sel_hi:[1,0,1]
    v_pk_fma_f32 v[200:201], v[224:225], v[34:35], v[200:201] op_sel_hi:[1,0,1]
    v_pk_fma_f32 v[202:203], v[226:227], v[34:35], v[202:203] op_sel_hi:[1,0,1]
    v_pk_fma_f32 v[204:205], v[228:229], v[34:35], v[204:205] op_sel_hi:[1,0,1]
    v_pk_fma_f32 v[206:207], v[230:231], v[34:35], v[206:207] op_sel_hi:[1,0,1]
    v_pk_fma_f32 v[208:209], v[232:233], v[34:35], v[208:209] op_sel_hi:[1,0,1]
    v_pk_fma_f32 v[210:211], v[234:235], v[34:35], v[210:211] op_sel_hi:[1,0,1]
    v_pk_fma_f32 v[212:213], v[236:237], v[34:35], v[212:213] op_sel_hi:[1,0,1]
    v_pk_fma_f32 v[214:215], v[238:239], v[34:35], v[214:215] op_sel_hi:[1,0,1]
    v_pk_mul_f32 v[192:193], v[192:193], v[38:39] op_sel:[0,0] op_sel_hi:[1,0]
    v_pk_mul_f32 v[194:195], v[194:195], v[38:39] op_sel:[0,0] op_sel_hi:[1,0]
    v_pk_mul_f32 v[196:197], v[196:197], v[38:39] op_sel:[0,0] op_sel_hi:[1,0]
    v_pk_mul_f32 v[198:199], v[198:199], v[38:39] op_sel:[0,0] op_sel_hi:[1,0]
    v_pk_mul_f32 v[200:201], v[200:201], v[38:39] op_sel:[0,0] op_sel_hi:[1,0]
    v_pk_mul_f32 v[202:203], v[202:203], v[38:39] op_sel:[0,0] op_sel_hi:[1,0]
    v_pk_mul_f32 v[204:205], v[204:205], v[38:39] op_sel:[0,1] op_sel_hi:[1,1]
    v_pk_mul_f32 v[206:207], v[206:207], v[38:39] op_sel:[0,1] op_sel_hi:[1,1]
    v_pk_mul_f32 v[208:209], v[208:209], v[38:39] op_sel:[0,1] op_sel_hi:[1,1]
    v_pk_mul_f32 v[210:211], v[210:211], v[38:39] op_sel:[0,1] op_sel_hi:[1,1]
    v_pk_mul_f32 v[212:213], v[212:213], v[38:39] op_sel:[0,1] op_sel_hi:[1,1]
    v_pk_mul_f32 v[214:215], v[214:215], v[38:39] op_sel:[0,1] op_sel_hi:[1,1]
    v_cvt_pk_bf16_f32 v216, v192, v193
    v_cvt_pk_bf16_f32 v217, v194, v195
    v_cvt_pk_bf16_f32 v218, v196, v197
    v_cvt_pk_bf16_f32 v219, v198, v199
    v_cvt_pk_bf16_f32 v220, v200, v201
    v_cvt_pk_bf16_f32 v221, v202, v203
    v_cvt_pk_bf16_f32 v222, v204, v205
    v_cvt_pk_bf16_f32 v223, v206, v207
    v_cvt_pk_bf16_f32 v224, v208, v209
    v_cvt_pk_bf16_f32 v225, v210, v211
    v_cvt_pk_bf16_f32 v226, v212, v213
    v_cvt_pk_bf16_f32 v227, v214, v215
    v_xor_b32 v228, 0x80008000, v222
    v_xor_b32 v229, 0x80008000, v223
    v_xor_b32 v230, 0x80008000, v224
    v_xor_b32 v231, 0x80008000, v225
    v_xor_b32 v232, 0x80008000, v226
    v_xor_b32 v233, 0x80008000, v227
    ds_write_b64 v31, v[216:217] offset:0
    ds_write_b64 v31, v[218:219] offset:2560
    ds_write_b64 v31, v[220:221] offset:5120
    ds_write_b64 v31, v[222:223] offset:7680
    ds_write_b64 v31, v[224:225] offset:10240
    ds_write_b64 v31, v[226:227] offset:12800
    ds_write_b64 v31, v[228:229] offset:15360
    ds_write_b64 v31, v[230:231] offset:17920
    ds_write_b64 v31, v[232:233] offset:20480
    v_mul_f32 v40, 0xbfb8aa3b, v168
    v_exp_f32 v40, v40
    v_lshlrev_b32 v22, 16, v22
    v_add_f32 v40, 1.0, v40
    v_rcp_f32 v40, v40
    s_nop 0
    v_sub_f32 v41, 1.0, v40
    s_nop 0
    v_bfe_u32 v45, v0, 2, 2
    v_and_b32 v44, 3, v0
    v_lshl_add_u32 v45, v45, 3, v44
    v_mul_u32_u24 v45, 160, v45
    v_lshlrev_b32 v46, 4, v3
    v_add_u32 v46, 106496, v46
    v_add_u32 v48, v46, v45
    v_sub_u32 v49, v46, v45
    v_add_u32 v49, 5760, v49
    v_mul_u32_u24 v44, 160, v44
    v_add_u32 v45, 5120, v44
    v_sub_u32 v47, 1280, v44
    v_cmp_gt_u32 vcc, 8, v8
    s_nop 1
    v_cndmask_b32 v45, v47, v45, vcc
    v_add_u32 v50, v45, v46
    v_mov_b32 v51, v50
    v_add_u32 v45, 5760, v44
    v_sub_u32 v47, 640, v44
    v_cmp_gt_u32 vcc, 8, v8
    s_nop 1
    v_cndmask_b32 v45, v47, v45, vcc
    v_add_u32 v52, v45, v46
    v_mov_b32 v53, v52
    v_bfe_u32 v44, v0, 3, 1
    v_bfe_u32 v45, v0, 2, 1
    v_add_u32 v47, 1, v44
    v_mul_u32_u24 v47, v47, v45
    v_mul_u32_u24 v47, 7680, v47
    v_add_u32 v50, v50, v47
    v_add_u32 v52, v52, v47
    v_sub_u32 v47, 2, v44
    v_xor_b32 v45, 1, v45
    v_mul_u32_u24 v47, v47, v45
    v_mul_u32_u24 v47, 7680, v47
    v_add_u32 v51, v51, v47
    v_add_u32 v53, v53, v47
    s_mul_i32 s68, s50, 165888
    s_mul_i32 s69, s48, 320
    s_add_u32 s68, s68, s69
    s_add_u32 s68, s68, 8388608
    s_lshr_b32 s69, s49, 1
    s_mul_i32 s69, s69, 663552
    s_and_b32 s70, s49, 1
    s_mul_i32 s70, s70, 10240
    s_add_u32 s69, s69, s70
    s_add_u32 s78, s68, s69
    s_sub_u32 s79, s68, s69
    s_add_u32 s79, s79, 4655104
    v_and_b32 v45, 7, v0
    v_mul_u32_u24 v45, 20736, v45
    v_lshl_add_u32 v46, v44, 6, v45
    v_lshl_add_u32 v54, v3, 4, v46
    v_lshl_add_u32 v46, v44, 5, v45
    v_and_b32 v45, 16, v0
    v_add_u32 v46, v46, v45
    v_add_u32 v45, s78, v46
    v_add_u32 v46, s79, v46
    v_cmp_gt_u32 vcc, 32, v0
    s_nop 1
    v_cndmask_b32 v55, v46, v45, vcc
    v_mov_b32 v188, -1
    v_mov_b32 v189, -1
    v_mov_b32 v190, -1
    v_mov_b32 v191, -1
    s_add_u32 s68, s85, 16384
    buffer_store_dwordx4 v[188:191], v2, s[28:31], s68 offen sc1
    s_waitcnt lgkmcnt(0)
    s_barrier
    s_add_u32 m0, s60, 12288
    s_add_u32 s73, s59, 196608
    buffer_load_dwordx4 v4, s[8:11], s73 offen lds
    ds_read_b128 a[200:203], v48 offset:0
    buffer_load_dwordx4 v5, s[8:11], s73 offen offset:1024 lds
    ds_read_b128 a[232:235], v48 offset:64
    buffer_load_dwordx4 v6, s[8:11], s73 offen offset:2048 lds
    ds_read_b128 a[204:207], v48 offset:15360
    s_add_u32 m0, s60, 49152
    s_add_u32 s73, s59, 393216
    buffer_load_dwordx4 v4, s[8:11], s73 offen lds
    ds_read_b128 a[236:239], v48 offset:15424
    ds_read_b128 a[208:211], v48 offset:640
    ds_read_b128 a[240:243], v48 offset:704
    ds_read_b128 a[212:215], v48 offset:16000
    ds_read_b128 a[244:247], v48 offset:16064
    s_waitcnt lgkmcnt(4)
    v_mfma_f32_16x16x32_bf16 v[192:195], a[200:203], a[192:195], 0
    buffer_load_dwordx4 v5, s[8:11], s73 offen offset:1024 lds
    ds_read_b128 a[216:219], v48 offset:7680
    v_mfma_f32_16x16x32_bf16 v[192:195], a[232:235], a[224:227], v[192:195]
    ds_read_b128 a[248:251], v48 offset:7744
    v_mfma_f32_16x16x32_bf16 v[192:195], a[204:207], a[196:199], v[192:195]
    ds_read_b128 a[220:223], v48 offset:0
    v_mfma_f32_16x16x32_bf16 v[192:195], a[236:239], a[228:231], v[192:195]
    ds_read_b128 a[252:255], v48 offset:64
    s_waitcnt lgkmcnt(4)
    v_mfma_f32_16x16x32_bf16 v[196:199], a[208:211], a[192:195], 0
    buffer_load_dwordx4 v6, s[8:11], s73 offen offset:2048 lds
    ds_read_b128 a[200:203], v48 offset:8320
    v_mfma_f32_16x16x32_bf16 v[196:199], a[240:243], a[224:227], v[196:199]
    ds_read_b128 a[232:235], v48 offset:8384
    v_mfma_f32_16x16x32_bf16 v[196:199], a[212:215], a[196:199], v[196:199]
    ds_read_b128 a[204:207], v48 offset:640
    v_mfma_f32_16x16x32_bf16 v[196:199], a[244:247], a[228:231], v[196:199]
    ds_read_b128 a[236:239], v48 offset:704
    s_waitcnt lgkmcnt(4)
    v_mfma_f32_16x16x32_bf16 v[200:203], a[216:219], a[192:195], 0
    s_add_u32 m0, s60, 61440
    s_add_u32 s73, s59, 589824
    buffer_load_dwordx4 v4, s[8:11], s73 offen lds
    ds_read_b128 a[208:211], v49 offset:640
    v_mfma_f32_16x16x32_bf16 v[200:203], a[248:251], a[224:227], v[200:203]
    ds_read_b128 a[240:243], v49 offset:704
    v_mfma_f32_16x16x32_bf16 v[200:203], a[220:223], a[196:199], v[200:203]
    ds_read_b128 a[212:215], v49 offset:8320
    v_mfma_f32_16x16x32_bf16 v[200:203], a[252:255], a[228:231], v[200:203]
    ds_read_b128 a[244:247], v49 offset:8384
    s_waitcnt lgkmcnt(4)
    v_mfma_f32_16x16x32_bf16 v[204:207], a[200:203], a[192:195], 0
    buffer_load_dwordx4 v5, s[8:11], s73 offen offset:1024 lds
    ds_read_b128 a[216:219], v49 offset:0
    v_cvt_pk_bf16_f32 v168, v192, v193
    v_mfma_f32_16x16x32_bf16 v[204:207], a[232:235], a[224:227], v[204:207]
    ds_read_b128 a[248:251], v49 offset:64
    v_cvt_pk_bf16_f32 v169, v194, v195
    v_mfma_f32_16x16x32_bf16 v[204:207], a[204:207], a[196:199], v[204:207]
    ds_read_b128 a[220:223], v49 offset:7680
    v_cvt_pk_bf16_f32 v170, v196, v197
    v_mfma_f32_16x16x32_bf16 v[204:207], a[236:239], a[228:231], v[204:207]
    ds_read_b128 a[252:255], v49 offset:7744
    buffer_load_dwordx4 v6, s[8:11], s73 offen offset:2048 lds
    v_cvt_pk_bf16_f32 v171, v198, v199
    s_waitcnt lgkmcnt(4)
    v_mfma_f32_16x16x32_bf16 v[208:211], a[208:211], a[192:195], 0
    ds_read_b128 a[200:203], v49 offset:16000
    buffer_store_dwordx4 v[168:171], v54, s[28:31], s78 offen offset:0 sc1
    v_mfma_f32_16x16x32_bf16 v[208:211], a[240:243], a[224:227], v[208:211]
    ds_read_b128 a[232:235], v49 offset:16064
    v_mfma_f32_16x16x32_bf16 v[208:211], a[212:215], a[196:199], v[208:211]
    ds_read_b128 a[204:207], v49 offset:640
    v_mfma_f32_16x16x32_bf16 v[208:211], a[244:247], a[228:231], v[208:211]
    ds_read_b128 a[236:239], v49 offset:704
    s_waitcnt lgkmcnt(4)
    v_mfma_f32_16x16x32_bf16 v[212:215], a[216:219], a[192:195], 0
    ds_read_b128 a[208:211], v49 offset:15360
    v_cvt_pk_bf16_f32 v172, v200, v201
    v_mfma_f32_16x16x32_bf16 v[212:215], a[248:251], a[224:227], v[212:215]
    ds_read_b128 a[240:243], v49 offset:15424
    v_cvt_pk_bf16_f32 v173, v202, v203
    v_mfma_f32_16x16x32_bf16 v[212:215], a[220:223], a[196:199], v[212:215]
    ds_read_b128 a[212:215], v49 offset:0
    v_cvt_pk_bf16_f32 v174, v204, v205
    v_mfma_f32_16x16x32_bf16 v[212:215], a[252:255], a[228:231], v[212:215]
    ds_read_b128 a[244:247], v49 offset:64
    v_cvt_pk_bf16_f32 v175, v206, v207
    s_waitcnt lgkmcnt(4)
    v_mfma_f32_16x16x32_bf16 v[216:219], a[200:203], a[192:195], 0
    ds_read_b128 a[216:219], v50 offset:0
    buffer_store_dwordx4 v[172:175], v54, s[28:31], s78 offen offset:128 sc1
    v_mfma_f32_16x16x32_bf16 v[216:219], a[232:235], a[224:227], v[216:219]
    ds_read_b128 a[248:251], v50 offset:64
    v_mfma_f32_16x16x32_bf16 v[216:219], a[204:207], a[196:199], v[216:219]
    ds_read_b128 a[220:223], v51 offset:0
    v_mfma_f32_16x16x32_bf16 v[216:219], a[236:239], a[228:231], v[216:219]
    ds_read_b128 a[252:255], v51 offset:64
    s_waitcnt lgkmcnt(4)
    v_mfma_f32_16x16x32_bf16 v[220:223], a[208:211], a[192:195], 0
    ds_read_b128 a[200:203], v52 offset:0
    v_cvt_pk_bf16_f32 v176, v208, v209
    v_mfma_f32_16x16x32_bf16 v[220:223], a[240:243], a[224:227], v[220:223]
    ds_read_b128 a[232:235], v52 offset:64
    v_cvt_pk_bf16_f32 v177, v210, v211
    v_mfma_f32_16x16x32_bf16 v[220:223], a[212:215], a[196:199], v[220:223]
    ds_read_b128 a[204:207], v53 offset:0
    v_cvt_pk_bf16_f32 v178, v212, v213
    v_mfma_f32_16x16x32_bf16 v[220:223], a[244:247], a[228:231], v[220:223]
    ds_read_b128 a[236:239], v53 offset:64
    v_cvt_pk_bf16_f32 v179, v214, v215
    s_waitcnt lgkmcnt(4)
    v_mfma_f32_16x16x32_bf16 v[224:227], a[216:219], a[192:195], 0
    buffer_store_dwordx4 v[176:179], v54, s[28:31], s79 offen offset:0 sc1
    v_mfma_f32_16x16x32_bf16 v[224:227], a[248:251], a[224:227], v[224:227]
    v_mfma_f32_16x16x32_bf16 v[224:227], a[220:223], a[196:199], v[224:227]
    v_mfma_f32_16x16x32_bf16 v[224:227], a[252:255], a[228:231], v[224:227]
    s_lshl_b32 s71, s49, 2
    s_add_u32 s71, s71, s50
    s_lshl_b32 s71, s71, 5
    s_add_u32 s71, s71, s48
    s_lshl_b32 s71, s71, 2
    s_add_u32 s71, s71, 4096
    s_waitcnt vmcnt(13)
    s_mov_b64 exec, 1
    buffer_store_dword v14, v13, s[28:31], s71 offen sc1
    s_mov_b64 exec, -1
    s_waitcnt lgkmcnt(0)
    v_mfma_f32_16x16x32_bf16 v[228:231], a[200:203], a[192:195], 0
    v_cvt_pk_bf16_f32 v180, v216, v217
    v_mfma_f32_16x16x32_bf16 v[228:231], a[232:235], a[224:227], v[228:231]
    v_cvt_pk_bf16_f32 v181, v218, v219
    v_mfma_f32_16x16x32_bf16 v[228:231], a[204:207], a[196:199], v[228:231]
    v_cvt_pk_bf16_f32 v182, v220, v221
    v_mfma_f32_16x16x32_bf16 v[228:231], a[236:239], a[228:231], v[228:231]
    ds_read_b128 a[192:195], v18 offset:8192
    ds_read_b128 a[224:227], v19 offset:8192
    v_cvt_pk_bf16_f32 v183, v222, v223
    ds_read_b128 a[196:199], v18 offset:10240
    ds_read_b128 a[228:231], v19 offset:10240
    buffer_store_dwordx4 v[180:183], v54, s[28:31], s79 offen offset:128 sc1
    ds_read_b128 a[200:203], v18 offset:12288
    ds_read_b128 a[232:235], v19 offset:12288
    v_cvt_pk_bf16_f32 v184, v224, v225
    ds_read_b128 a[204:207], v18 offset:14336
    ds_read_b128 a[236:239], v19 offset:14336
    v_cvt_pk_bf16_f32 v185, v226, v227
    ds_read_b128 a[208:211], v18 offset:16384
    ds_read_b128 a[240:243], v19 offset:16384
    v_cvt_pk_bf16_f32 v186, v228, v229
    ds_read_b128 a[212:215], v18 offset:18432
    ds_read_b128 a[244:247], v19 offset:18432
    v_cvt_pk_bf16_f32 v187, v230, v231
    ds_read_b128 a[216:219], v18 offset:0
    ds_read_b128 a[248:251], v19 offset:0
    buffer_store_dwordx4 v[184:187], v55, s[28:31], 0 offen offset:256 sc1
    ds_read_b128 a[220:223], v18 offset:2048
    ds_read_b128 a[252:255], v19 offset:2048
    s_barrier
    ds_read_b64_tr_b16 v[192:193], v9 offset:0
    ds_read_b64_tr_b16 v[194:195], v9 offset:768
    ds_read_b64_tr_b16 v[196:197], v10 offset:32
    ds_read_b64_tr_b16 v[198:199], v10 offset:800
    ds_read_b64_tr_b16 v[200:201], v9 offset:64
    ds_read_b64_tr_b16 v[202:203], v9 offset:832
    ds_read_b64_tr_b16 v[204:205], v10 offset:96
    ds_read_b64_tr_b16 v[206:207], v10 offset:864
    ds_read_b64_tr_b16 v[208:209], v9 offset:128
    ds_read_b64_tr_b16 v[210:211], v9 offset:896
    ds_read_b64_tr_b16 v[212:213], v10 offset:160
    ds_read_b64_tr_b16 v[214:215], v10 offset:928
    s_waitcnt lgkmcnt(0)
    v_mfma_f32_16x16x32_bf16 v[168:171], v[192:195], v[64:67], 0
    ds_read_b64_tr_b16 v[216:217], v9 offset:6144
    ds_read_b64_tr_b16 v[218:219], v9 offset:6912
    ds_read_b64_tr_b16 v[220:221], v10 offset:6176
    v_and_b32 v24, 124, v15
    v_mfma_f32_16x16x32_bf16 v[172:175], v[196:199], v[64:67], 0
    ds_read_b64_tr_b16 v[222:223], v10 offset:6944
    ds_read_b64_tr_b16 v[224:225], v9 offset:6208
    ds_read_b64_tr_b16 v[226:227], v9 offset:6976
    v_bfe_u32 v144, v0, 4, 1
    v_mfma_f32_16x16x32_bf16 v[176:179], v[200:203], v[64:67], 0
    ds_read_b64_tr_b16 v[228:229], v10 offset:6240
    ds_read_b64_tr_b16 v[230:231], v10 offset:7008
    ds_read_b64_tr_b16 v[232:233], v9 offset:6272
    v_mul_u32_u24 v144, 2056, v144
    v_mfma_f32_16x16x32_bf16 v[180:183], v[204:207], v[64:67], 0
    ds_read_b64_tr_b16 v[234:235], v9 offset:7040
    ds_read_b64_tr_b16 v[236:237], v10 offset:6304
    ds_read_b64_tr_b16 v[238:239], v10 offset:7072
    v_bfe_u32 v145, v0, 2, 2
    v_mfma_f32_16x16x32_bf16 v[184:187], v[208:211], v[64:67], 0
    v_lshl_add_u32 v144, v145, 8, v144
    v_xor_b32 v145, v145, v7
    v_lshl_add_u32 v144, v145, 6, v144
    v_and_b32 v145, 3, v0
    v_mfma_f32_16x16x32_bf16 v[188:191], v[212:215], v[64:67], 0
    s_waitcnt vmcnt(12) lgkmcnt(0)
    s_barrier
    v_lshl_add_u32 v144, v145, 4, v144
    s_and_b32 s68, s46, 1
    s_lshl_b32 s68, s68, 7
    v_xor_b32 v144, s68, v144
    v_add_u32 v25, s55, v144
    v_mfma_f32_16x16x32_bf16 v[168:171], v[216:219], v[68:71], v[168:171]
    ds_read_b64_tr_b16 v[192:193], v9 offset:12288
    ds_read_b64_tr_b16 v[194:195], v9 offset:13056
    ds_read_b64_tr_b16 v[196:197], v10 offset:12320
    v_xor_b32 v26, 8, v25
    v_mfma_f32_16x16x32_bf16 v[172:175], v[220:223], v[68:71], v[172:175]
    ds_read_b64_tr_b16 v[198:199], v10 offset:13088
    ds_read_b64_tr_b16 v[200:201], v9 offset:12352
    ds_read_b64_tr_b16 v[202:203], v9 offset:13120
    v_xor_b32 v27, 128, v25
    v_mfma_f32_16x16x32_bf16 v[176:179], v[224:227], v[68:71], v[176:179]
    ds_read_b64_tr_b16 v[204:205], v10 offset:12384
    ds_read_b64_tr_b16 v[206:207], v10 offset:13152
    ds_read_b64_tr_b16 v[208:209], v9 offset:12416
    v_xor_b32 v28, 136, v25
    v_mfma_f32_16x16x32_bf16 v[180:183], v[228:231], v[68:71], v[180:183]
    ds_read_b64_tr_b16 v[210:211], v9 offset:13184
    ds_read_b64_tr_b16 v[212:213], v10 offset:12448
    ds_read_b64_tr_b16 v[214:215], v10 offset:13216
    s_add_u32 m0, s60, 0
    s_add_u32 s73, s59, 786432
    buffer_load_dwordx4 v4, s[8:11], s73 offen lds
    v_mfma_f32_16x16x32_bf16 v[184:187], v[232:235], v[68:71], v[184:187]
    buffer_load_dwordx4 v5, s[8:11], s73 offen offset:1024 lds
    s_lshr_b32 s68, s46, 1
    s_lshl_b32 s68, s68, 13
    s_add_u32 s65, s65, s68
    s_xor_b32 s47, s65, 8192
    s_xor_b32 s57, s65, 16384
    s_xor_b32 s66, s65, 24576
    v_mfma_f32_16x16x32_bf16 v[188:191], v[236:239], v[68:71], v[188:191]
    s_mul_i32 s68, s50, 6144
    s_add_u32 s68, s68, 139264
    v_add_u32 v29, s68, v2
    s_waitcnt lgkmcnt(0)
    v_mfma_f32_16x16x32_bf16 v[168:171], v[192:195], v[72:75], v[168:171]
    ds_read_b64_tr_b16 v[216:217], v9 offset:18432
    ds_read_b64_tr_b16 v[218:219], v9 offset:19200
    ds_read_b64_tr_b16 v[220:221], v10 offset:18464
    v_mfma_f32_16x16x32_bf16 v[172:175], v[196:199], v[72:75], v[172:175]
    ds_read_b64_tr_b16 v[222:223], v10 offset:19232
    ds_read_b64_tr_b16 v[224:225], v9 offset:18496
    ds_read_b64_tr_b16 v[226:227], v9 offset:19264
    v_mfma_f32_16x16x32_bf16 v[176:179], v[200:203], v[72:75], v[176:179]
    ds_read_b64_tr_b16 v[228:229], v10 offset:18528
    ds_read_b64_tr_b16 v[230:231], v10 offset:19296
    ds_read_b64_tr_b16 v[232:233], v9 offset:18560
    v_mfma_f32_16x16x32_bf16 v[180:183], v[204:207], v[72:75], v[180:183]
    ds_read_b64_tr_b16 v[234:235], v9 offset:19328
    ds_read_b64_tr_b16 v[236:237], v10 offset:18592
    ds_read_b64_tr_b16 v[238:239], v10 offset:19360
    buffer_load_dwordx4 v6, s[8:11], s73 offen offset:2048 lds
    v_mfma_f32_16x16x32_bf16 v[184:187], v[208:211], v[72:75], v[184:187]
    s_xor_b32 s68, s50, 1
    s_mul_i32 s68, s68, 6144
    s_add_u32 s68, s68, 139264
    v_add_u32 v30, s68, v2
    v_mfma_f32_16x16x32_bf16 v[188:191], v[212:215], v[72:75], v[188:191]
    s_waitcnt vmcnt(12) lgkmcnt(0)
    s_barrier
    s_xor_b32 s68, s50, 2
    s_mul_i32 s68, s68, 6144
    s_add_u32 s68, s68, 141312
    v_add_u32 v31, s68, v2
    v_mfma_f32_16x16x32_bf16 v[168:171], v[216:219], v[76:79], v[168:171]
    ds_read_b64_tr_b16 v[192:193], v11 offset:0
    ds_read_b64_tr_b16 v[194:195], v11 offset:768
    ds_read_b64_tr_b16 v[196:197], v12 offset:32
    v_mfma_f32_16x16x32_bf16 v[172:175], v[220:223], v[76:79], v[172:175]
    ds_read_b64_tr_b16 v[198:199], v12 offset:800
    ds_read_b64_tr_b16 v[200:201], v11 offset:64
    ds_read_b64_tr_b16 v[202:203], v11 offset:832
    v_mfma_f32_16x16x32_bf16 v[176:179], v[224:227], v[76:79], v[176:179]
    ds_read_b64_tr_b16 v[204:205], v12 offset:96
    ds_read_b64_tr_b16 v[206:207], v12 offset:864
    ds_read_b64_tr_b16 v[208:209], v11 offset:128
    v_mfma_f32_16x16x32_bf16 v[180:183], v[228:231], v[76:79], v[180:183]
    ds_read_b64_tr_b16 v[210:211], v11 offset:896
    ds_read_b64_tr_b16 v[212:213], v12 offset:160
    ds_read_b64_tr_b16 v[214:215], v12 offset:928
    s_add_u32 m0, s60, 12288
    s_add_u32 s73, s89, 983040
    buffer_load_dwordx4 v4, s[8:11], s73 offen lds
    v_mfma_f32_16x16x32_bf16 v[184:187], v[232:235], v[76:79], v[184:187]
    buffer_load_dwordx4 v5, s[8:11], s73 offen offset:1024 lds
    s_xor_b32 s68, s50, 3
    s_mul_i32 s68, s68, 6144
    s_add_u32 s68, s68, 143360
    v_add_u32 v32, s68, v2
    v_mfma_f32_16x16x32_bf16 v[188:191], v[236:239], v[76:79], v[188:191]
    v_mov_b32 v34, v2
    v_add_u32 v33, 81920, v34
    v_add_u32 v35, 40960, v34
    v_and_b32 v36, 28, v15
    s_waitcnt lgkmcnt(0)
    v_mfma_f32_16x16x32_bf16 v[168:171], v[192:195], v[80:83], v[168:171]
    ds_read_b64_tr_b16 v[216:217], v11 offset:6144
    ds_read_b64_tr_b16 v[218:219], v11 offset:6912
    ds_read_b64_tr_b16 v[220:221], v12 offset:6176
    v_mul_u32_u24 v144, 40960, v8
    v_mfma_f32_16x16x32_bf16 v[172:175], v[196:199], v[80:83], v[172:175]
    ds_read_b64_tr_b16 v[222:223], v12 offset:6944
    ds_read_b64_tr_b16 v[224:225], v11 offset:6208
    ds_read_b64_tr_b16 v[226:227], v11 offset:6976
    v_lshl_add_u32 v38, v3, 3, v144
    v_mfma_f32_16x16x32_bf16 v[176:179], v[200:203], v[80:83], v[176:179]
    ds_read_b64_tr_b16 v[228:229], v12 offset:6240
    ds_read_b64_tr_b16 v[230:231], v12 offset:7008
    ds_read_b64_tr_b16 v[232:233], v11 offset:6272
    v_lshl_add_u32 v144, v7, 4, v144
    v_mfma_f32_16x16x32_bf16 v[180:183], v[204:207], v[80:83], v[180:183]
    ds_read_b64_tr_b16 v[234:235], v11 offset:7040
    ds_read_b64_tr_b16 v[236:237], v12 offset:6304
    ds_read_b64_tr_b16 v[238:239], v12 offset:7072
    buffer_load_dwordx4 v6, s[8:11], s73 offen offset:2048 lds
    v_mfma_f32_16x16x32_bf16 v[184:187], v[208:211], v[80:83], v[184:187]
    v_bfe_u32 v145, v0, 4, 1
    v_lshl_add_u32 v37, v145, 5, v144
    v_bfe_u32 v144, v0, 2, 2
    v_lshl_add_u32 v144, v3, 3, v144
    v_mfma_f32_16x16x32_bf16 v[188:191], v[212:215], v[80:83], v[188:191]
    s_lshl_b32 s71, s49, 2
    s_add_u32 s71, s71, s50
    s_lshl_b32 s71, s71, 5
    s_add_u32 s71, s71, s48
    s_lshl_b32 s71, s71, 2
    s_add_u32 s71, s71, 8192
    s_waitcnt vmcnt(6)
    s_mov_b64 exec, 1
    buffer_store_dword v14, v13, s[28:31], s71 offen sc1
    s_mov_b64 exec, -1
    s_waitcnt lgkmcnt(0)
    s_barrier
    v_mfma_f32_16x16x32_bf16 v[168:171], v[216:219], v[84:87], v[168:171]
    ds_read_b64_tr_b16 v[192:193], v11 offset:12288
    ds_read_b64_tr_b16 v[194:195], v11 offset:13056
    ds_read_b64_tr_b16 v[196:197], v12 offset:12320
    v_mul_u32_u24 v144, 320, v144
    v_mfma_f32_16x16x32_bf16 v[172:175], v[220:223], v[84:87], v[172:175]
    ds_read_b64_tr_b16 v[198:199], v12 offset:13088
    ds_read_b64_tr_b16 v[200:201], v11 offset:12352
    ds_read_b64_tr_b16 v[202:203], v11 offset:13120
    v_and_b32 v145, 3, v0
    v_mfma_f32_16x16x32_bf16 v[176:179], v[224:227], v[84:87], v[176:179]
    ds_read_b64_tr_b16 v[204:205], v12 offset:12384
    ds_read_b64_tr_b16 v[206:207], v12 offset:13152
    ds_read_b64_tr_b16 v[208:209], v11 offset:12416
    v_lshl_add_u32 v144, v145, 3, v144
    v_mfma_f32_16x16x32_bf16 v[180:183], v[228:231], v[84:87], v[180:183]
    ds_read_b64_tr_b16 v[210:211], v11 offset:13184
    ds_read_b64_tr_b16 v[212:213], v12 offset:12448
    ds_read_b64_tr_b16 v[214:215], v12 offset:13216
    s_add_u32 m0, s60, 49152
    s_add_u32 s73, s89, 1179648
    buffer_load_dwordx4 v4, s[8:11], s73 offen lds
    v_mfma_f32_16x16x32_bf16 v[184:187], v[232:235], v[84:87], v[184:187]
    buffer_load_dwordx4 v5, s[8:11], s73 offen offset:1024 lds
    v_add_u32 v49, 114688, v144
    v_mfma_f32_16x16x32_bf16 v[188:191], v[236:239], v[84:87], v[188:191]
    v_and_b32 v144, 2, v0
    v_cmp_eq_u32 vcc, 0, v144
    v_add_u32 v145, 256, v49
    v_add_u32 v146, 10224, v49
    v_cndmask_b32 v39, v146, v145, vcc
    v_add_u32 v145, 10288, v49
    v_add_u32 v146, 10480, v49
    v_cndmask_b32 v42, v146, v145, vcc
    s_waitcnt lgkmcnt(0)
    v_mfma_f32_16x16x32_bf16 v[168:171], v[192:195], v[88:91], v[168:171]
    ds_read_b64_tr_b16 v[216:217], v11 offset:18432
    ds_read_b64_tr_b16 v[218:219], v11 offset:19200
    ds_read_b64_tr_b16 v[220:221], v12 offset:18464
    v_mfma_f32_16x16x32_bf16 v[172:175], v[196:199], v[88:91], v[172:175]
    ds_read_b64_tr_b16 v[222:223], v12 offset:19232
    ds_read_b64_tr_b16 v[224:225], v11 offset:18496
    ds_read_b64_tr_b16 v[226:227], v11 offset:19264
    v_mfma_f32_16x16x32_bf16 v[176:179], v[200:203], v[88:91], v[176:179]
    ds_read_b64_tr_b16 v[228:229], v12 offset:18528
    ds_read_b64_tr_b16 v[230:231], v12 offset:19296
    ds_read_b64_tr_b16 v[232:233], v11 offset:18560
    v_mfma_f32_16x16x32_bf16 v[180:183], v[204:207], v[88:91], v[180:183]
    ds_read_b64_tr_b16 v[234:235], v11 offset:19328
    ds_read_b64_tr_b16 v[236:237], v12 offset:18592
    ds_read_b64_tr_b16 v[238:239], v12 offset:19360
    buffer_load_dwordx4 v6, s[8:11], s73 offen offset:2048 lds
    v_mfma_f32_16x16x32_bf16 v[184:187], v[208:211], v[88:91], v[184:187]
    v_and_b32 v144, 2, v0
    v_cmp_eq_u32 vcc, 0, v144
    v_add_u32 v145, 272, v49
    v_add_u32 v146, 10352, v49
    v_cndmask_b32 v43, v146, v145, vcc
    v_add_u32 v145, 10416, v49
    v_add_u32 v146, 10496, v49
    v_cndmask_b32 v44, v146, v145, vcc
    v_mfma_f32_16x16x32_bf16 v[188:191], v[212:215], v[88:91], v[188:191]
    s_lshl_b32 s75, s49, 2
    s_add_u32 s75, s75, s50
    s_lshl_b32 s75, s75, 7
    s_add_u32 s75, s75, 4096
    buffer_load_dword v50, v24, s[28:31], s75 offen sc1
    s_waitcnt vmcnt(8) lgkmcnt(0)
    s_barrier
    v_mfma_f32_16x16x32_bf16 v[168:171], v[216:219], v[92:95], v[168:171]
    ds_read_b64_tr_b16 v[192:193], v9 offset:0
    ds_read_b64_tr_b16 v[194:195], v9 offset:768
    ds_read_b64_tr_b16 v[196:197], v10 offset:32
    v_mfma_f32_16x16x32_bf16 v[172:175], v[220:223], v[92:95], v[172:175]
    ds_read_b64_tr_b16 v[198:199], v10 offset:800
    ds_read_b64_tr_b16 v[200:201], v9 offset:64
    ds_read_b64_tr_b16 v[202:203], v9 offset:832
    v_mfma_f32_16x16x32_bf16 v[176:179], v[224:227], v[92:95], v[176:179]
    ds_read_b64_tr_b16 v[204:205], v10 offset:96
    ds_read_b64_tr_b16 v[206:207], v10 offset:864
    ds_read_b64_tr_b16 v[208:209], v9 offset:128
    v_mfma_f32_16x16x32_bf16 v[180:183], v[228:231], v[92:95], v[180:183]
    ds_read_b64_tr_b16 v[210:211], v9 offset:896
    ds_read_b64_tr_b16 v[212:213], v10 offset:160
    ds_read_b64_tr_b16 v[214:215], v10 offset:928
    s_add_u32 m0, s60, 61440
    s_add_u32 s73, s89, 1376256
    buffer_load_dwordx4 v4, s[8:11], s73 offen lds
    v_mfma_f32_16x16x32_bf16 v[184:187], v[232:235], v[92:95], v[184:187]
    buffer_load_dwordx4 v5, s[8:11], s73 offen offset:1024 lds
    v_and_b32 v144, 2, v0
    v_cmp_eq_u32 vcc, 0, v144
    v_add_u32 v145, 288, v49
    v_add_u32 v146, 10288, v49
    v_cndmask_b32 v45, v146, v145, vcc
    v_add_u32 v145, 10352, v49
    v_add_u32 v146, 10512, v49
    v_cndmask_b32 v46, v146, v145, vcc
    v_mfma_f32_16x16x32_bf16 v[188:191], v[236:239], v[92:95], v[188:191]
    v_and_b32 v144, 2, v0
    v_cmp_eq_u32 vcc, 0, v144
    v_add_u32 v145, 304, v49
    v_add_u32 v146, 10416, v49
    v_cndmask_b32 v47, v146, v145, vcc
    v_add_u32 v145, 10480, v49
    v_add_u32 v146, 10528, v49
    v_cndmask_b32 v48, v146, v145, vcc
    s_waitcnt lgkmcnt(0)
    v_mfma_f32_16x16x32_bf16 v[168:171], v[192:195], v[96:99], v[168:171]
    ds_read_b64_tr_b16 v[216:217], v9 offset:6144
    ds_read_b64_tr_b16 v[218:219], v9 offset:6912
    ds_read_b64_tr_b16 v[220:221], v10 offset:6176
    v_mfma_f32_16x16x32_bf16 v[172:175], v[196:199], v[96:99], v[172:175]
    ds_read_b64_tr_b16 v[222:223], v10 offset:6944
    ds_read_b64_tr_b16 v[224:225], v9 offset:6208
    ds_read_b64_tr_b16 v[226:227], v9 offset:6976
    v_mfma_f32_16x16x32_bf16 v[176:179], v[200:203], v[96:99], v[176:179]
    ds_read_b64_tr_b16 v[228:229], v10 offset:6240
    ds_read_b64_tr_b16 v[230:231], v10 offset:7008
    ds_read_b64_tr_b16 v[232:233], v9 offset:6272
    v_mfma_f32_16x16x32_bf16 v[180:183], v[204:207], v[96:99], v[180:183]
    ds_read_b64_tr_b16 v[234:235], v9 offset:7040
    ds_read_b64_tr_b16 v[236:237], v10 offset:6304
    ds_read_b64_tr_b16 v[238:239], v10 offset:7072
    buffer_load_dwordx4 v6, s[8:11], s73 offen offset:2048 lds
    v_mfma_f32_16x16x32_bf16 v[184:187], v[208:211], v[96:99], v[184:187]
    s_mul_i32 s68, s49, 122880
    s_add_u32 s68, s68, 16777216
    s_mul_i32 s69, s50, 10240
    s_add_u32 s80, s68, s69
    s_lshl_b32 s83, s50, 13
    s_add_u32 s78, s68, s83
    s_lshl_b32 s84, s50, 11
    s_add_u32 s79, s68, s84
    v_mfma_f32_16x16x32_bf16 v[188:191], v[212:215], v[96:99], v[188:191]
    s_waitcnt vmcnt(8) lgkmcnt(0)
    s_barrier
    s_lshl_b32 s68, s50, 9
    s_add_u32 s68, s68, s48
    v_lshl_add_u32 v144, v8, 5, s68
    v_mfma_f32_16x16x32_bf16 v[168:171], v[216:219], v[100:103], v[168:171]
    ds_read_b64_tr_b16 v[192:193], v9 offset:12288
    ds_read_b64_tr_b16 v[194:195], v9 offset:13056
    ds_read_b64_tr_b16 v[196:197], v10 offset:12320
    v_cvt_f32_u32 v144, v144
    v_mfma_f32_16x16x32_bf16 v[172:175], v[220:223], v[100:103], v[172:175]
    ds_read_b64_tr_b16 v[198:199], v10 offset:13088
    ds_read_b64_tr_b16 v[200:201], v9 offset:12352
    ds_read_b64_tr_b16 v[202:203], v9 offset:13120
    v_mul_f32 v144, 0x3a000000, v144
    v_mfma_f32_16x16x32_bf16 v[176:179], v[224:227], v[100:103], v[176:179]
    ds_read_b64_tr_b16 v[204:205], v10 offset:12384
    ds_read_b64_tr_b16 v[206:207], v10 offset:13152
    ds_read_b64_tr_b16 v[208:209], v9 offset:12416
    v_cvt_f32_u32 v146, v3
    v_mfma_f32_16x16x32_bf16 v[180:183], v[228:231], v[100:103], v[180:183]
    ds_read_b64_tr_b16 v[210:211], v9 offset:13184
    ds_read_b64_tr_b16 v[212:213], v10 offset:12448
    ds_read_b64_tr_b16 v[214:215], v10 offset:13216
    s_add_u32 m0, s60, 0
    s_add_u32 s73, s89, 1572864
    buffer_load_dwordx4 v4, s[8:11], s73 offen lds
    v_mfma_f32_16x16x32_bf16 v[184:187], v[232:235], v[100:103], v[184:187]
    buffer_load_dwordx4 v5, s[8:11], s73 offen offset:1024 lds
    v_mul_f32 v146, 0x41000000, v146
    v_mul_f32 v146, v146, v144
    v_mfma_f32_16x16x32_bf16 v[188:191], v[236:239], v[100:103], v[188:191]
    v_add_f32 v147, v146, v144
    v_cos_f32 v148, v146
    v_cos_f32 v149, v147
    s_waitcnt lgkmcnt(0)
    v_mfma_f32_16x16x32_bf16 v[168:171], v[192:195], v[104:107], v[168:171]
    ds_read_b64_tr_b16 v[216:217], v9 offset:18432
    ds_read_b64_tr_b16 v[218:219], v9 offset:19200
    ds_read_b64_tr_b16 v[220:221], v10 offset:18464
    v_sin_f32 v150, v146
    v_mfma_f32_16x16x32_bf16 v[172:175], v[196:199], v[104:107], v[172:175]
    ds_read_b64_tr_b16 v[222:223], v10 offset:19232
    ds_read_b64_tr_b16 v[224:225], v9 offset:18496
    ds_read_b64_tr_b16 v[226:227], v9 offset:19264
    v_sin_f32 v151, v147
    v_mfma_f32_16x16x32_bf16 v[176:179], v[200:203], v[104:107], v[176:179]
    ds_read_b64_tr_b16 v[228:229], v10 offset:18528
    ds_read_b64_tr_b16 v[230:231], v10 offset:19296
    ds_read_b64_tr_b16 v[232:233], v9 offset:18560
    v_mul_f32 v148, v148, v40
    v_mfma_f32_16x16x32_bf16 v[180:183], v[204:207], v[104:107], v[180:183]
    ds_read_b64_tr_b16 v[234:235], v9 offset:19328
    ds_read_b64_tr_b16 v[236:237], v10 offset:18592
    ds_read_b64_tr_b16 v[238:239], v10 offset:19360
    buffer_load_dwordx4 v6, s[8:11], s73 offen offset:2048 lds
    v_mfma_f32_16x16x32_bf16 v[184:187], v[208:211], v[104:107], v[184:187]
    v_mul_f32 v149, v149, v40
    v_mul_f32 v150, v150, v40
    v_mul_f32 v151, v151, v40
    v_cvt_pk_bf16_f32 v240, v148, v149
    v_mfma_f32_16x16x32_bf16 v[188:191], v[212:215], v[104:107], v[188:191]
    s_waitcnt vmcnt(7) lgkmcnt(0)
    s_barrier
    v_cvt_pk_bf16_f32 v244, v150, v151
    v_add_f32 v146, v147, v144
    v_add_f32 v147, v146, v144
    v_mfma_f32_16x16x32_bf16 v[168:171], v[216:219], v[108:111], v[168:171]
    ds_read_b64_tr_b16 v[192:193], v11 offset:0
    ds_read_b64_tr_b16 v[194:195], v11 offset:768
    ds_read_b64_tr_b16 v[196:197], v12 offset:32
    v_cos_f32 v148, v146
    v_mfma_f32_16x16x32_bf16 v[172:175], v[220:223], v[108:111], v[172:175]
    ds_read_b64_tr_b16 v[198:199], v12 offset:800
    ds_read_b64_tr_b16 v[200:201], v11 offset:64
    ds_read_b64_tr_b16 v[202:203], v11 offset:832
    v_cos_f32 v149, v147
    v_mfma_f32_16x16x32_bf16 v[176:179], v[224:227], v[108:111], v[176:179]
    ds_read_b64_tr_b16 v[204:205], v12 offset:96
    ds_read_b64_tr_b16 v[206:207], v12 offset:864
    ds_read_b64_tr_b16 v[208:209], v11 offset:128
    v_sin_f32 v150, v146
    v_mfma_f32_16x16x32_bf16 v[180:183], v[228:231], v[108:111], v[180:183]
    ds_read_b64_tr_b16 v[210:211], v11 offset:896
    ds_read_b64_tr_b16 v[212:213], v12 offset:160
    ds_read_b64_tr_b16 v[214:215], v12 offset:928
    s_add_u32 m0, s60, 12288
    s_add_u32 s73, s89, 1769472
    buffer_load_dwordx4 v4, s[8:11], s73 offen lds
    v_mfma_f32_16x16x32_bf16 v[184:187], v[232:235], v[108:111], v[184:187]
    buffer_load_dwordx4 v5, s[8:11], s73 offen offset:1024 lds
    v_sin_f32 v151, v147
    v_mul_f32 v148, v148, v40
    v_mfma_f32_16x16x32_bf16 v[188:191], v[236:239], v[108:111], v[188:191]
    v_mul_f32 v149, v149, v40
    v_mul_f32 v150, v150, v40
    v_mul_f32 v151, v151, v40
    v_cvt_pk_bf16_f32 v241, v148, v149
    s_waitcnt lgkmcnt(0)
    v_mfma_f32_16x16x32_bf16 v[168:171], v[192:195], v[112:115], v[168:171]
    ds_read_b64_tr_b16 v[216:217], v11 offset:6144
    ds_read_b64_tr_b16 v[218:219], v11 offset:6912
    ds_read_b64_tr_b16 v[220:221], v12 offset:6176
    v_cvt_pk_bf16_f32 v245, v150, v151
    v_mfma_f32_16x16x32_bf16 v[172:175], v[196:199], v[112:115], v[172:175]
    ds_read_b64_tr_b16 v[222:223], v12 offset:6944
    ds_read_b64_tr_b16 v[224:225], v11 offset:6208
    ds_read_b64_tr_b16 v[226:227], v11 offset:6976
    v_add_f32 v146, v147, v144
    v_mfma_f32_16x16x32_bf16 v[176:179], v[200:203], v[112:115], v[176:179]
    ds_read_b64_tr_b16 v[228:229], v12 offset:6240
    ds_read_b64_tr_b16 v[230:231], v12 offset:7008
    ds_read_b64_tr_b16 v[232:233], v11 offset:6272
    v_add_f32 v147, v146, v144
    v_mfma_f32_16x16x32_bf16 v[180:183], v[204:207], v[112:115], v[180:183]
    ds_read_b64_tr_b16 v[234:235], v11 offset:7040
    ds_read_b64_tr_b16 v[236:237], v12 offset:6304
    ds_read_b64_tr_b16 v[238:239], v12 offset:7072
    buffer_load_dwordx4 v6, s[8:11], s73 offen offset:2048 lds
    v_mfma_f32_16x16x32_bf16 v[184:187], v[208:211], v[112:115], v[184:187]
    v_cos_f32 v148, v146
    v_cos_f32 v149, v147
    v_mfma_f32_16x16x32_bf16 v[188:191], v[212:215], v[112:115], v[188:191]
    s_waitcnt vmcnt(9)
    v_cmp_ne_u32 vcc, s53, v50
    s_nop 0
    s_cbranch_vccnz L_slow1
L_back1:
    s_add_u32 m0, s55, 4096
    s_add_u32 s73, s65, 0
    buffer_load_dwordx4 v2, s[28:31], s73 offen sc1 lds
    s_waitcnt vmcnt(7) lgkmcnt(0)
    s_barrier
    buffer_load_dwordx4 v2, s[28:31], s73 offen offset:1024 sc1 lds
    v_mfma_f32_16x16x32_bf16 v[168:171], v[216:219], v[116:119], v[168:171]
    buffer_load_dwordx4 v2, s[28:31], s73 offen offset:2048 sc1 lds
    ds_read_b64_tr_b16 v[192:193], v11 offset:12288
    buffer_load_dwordx4 v2, s[28:31], s73 offen offset:3072 sc1 lds
    ds_read_b64_tr_b16 v[194:195], v11 offset:13056
    ds_read_b64_tr_b16 v[196:197], v12 offset:12320
    v_mfma_f32_16x16x32_bf16 v[172:175], v[220:223], v[116:119], v[172:175]
    ds_read_b64_tr_b16 v[198:199], v12 offset:13088
    ds_read_b64_tr_b16 v[200:201], v11 offset:12352
    s_add_u32 m0, s55, 8192
    s_add_u32 s73, s65, 4096
    buffer_load_dwordx4 v2, s[28:31], s73 offen sc1 lds
    ds_read_b64_tr_b16 v[202:203], v11 offset:13120
    v_mfma_f32_16x16x32_bf16 v[176:179], v[224:227], v[116:119], v[176:179]
    ds_read_b64_tr_b16 v[204:205], v12 offset:12384
    ds_read_b64_tr_b16 v[206:207], v12 offset:13152
    ds_read_b64_tr_b16 v[208:209], v11 offset:12416
    v_sin_f32 v150, v146
    v_mfma_f32_16x16x32_bf16 v[180:183], v[228:231], v[116:119], v[180:183]
    ds_read_b64_tr_b16 v[210:211], v11 offset:13184
    ds_read_b64_tr_b16 v[212:213], v12 offset:12448
    ds_read_b64_tr_b16 v[214:215], v12 offset:13216
    buffer_load_dwordx4 v2, s[28:31], s73 offen offset:1024 sc1 lds
    v_mfma_f32_16x16x32_bf16 v[184:187], v[232:235], v[116:119], v[184:187]
    v_sin_f32 v151, v147
    v_mul_f32 v148, v148, v40
    v_mul_f32 v149, v149, v40
    v_mul_f32 v150, v150, v40
    v_mfma_f32_16x16x32_bf16 v[188:191], v[236:239], v[116:119], v[188:191]
    v_mul_f32 v151, v151, v40
    v_cvt_pk_bf16_f32 v242, v148, v149
    v_cvt_pk_bf16_f32 v246, v150, v151
    v_add_f32 v146, v147, v144
    s_waitcnt lgkmcnt(0)
    v_mfma_f32_16x16x32_bf16 v[168:171], v[192:195], v[120:123], v[168:171]
    buffer_load_dwordx4 v2, s[28:31], s73 offen offset:2048 sc1 lds
    ds_read_b64_tr_b16 v[216:217], v11 offset:18432
    ds_read_b64_tr_b16 v[218:219], v11 offset:19200
    ds_read_b64_tr_b16 v[220:221], v12 offset:18464
    v_mfma_f32_16x16x32_bf16 v[172:175], v[196:199], v[120:123], v[172:175]
    ds_read_b64_tr_b16 v[222:223], v12 offset:19232
    ds_read_b64_tr_b16 v[224:225], v11 offset:18496
    ds_read_b64_tr_b16 v[226:227], v11 offset:19264
    v_add_f32 v147, v146, v144
    v_mfma_f32_16x16x32_bf16 v[176:179], v[200:203], v[120:123], v[176:179]
    ds_read_b64_tr_b16 v[228:229], v12 offset:18528
    buffer_load_dwordx4 v2, s[28:31], s73 offen offset:3072 sc1 lds
    ds_read_b64_tr_b16 v[230:231], v12 offset:19296
    ds_read_b64_tr_b16 v[232:233], v11 offset:18560
    v_mfma_f32_16x16x32_bf16 v[180:183], v[204:207], v[120:123], v[180:183]
    ds_read_b64_tr_b16 v[234:235], v11 offset:19328
    ds_read_b64_tr_b16 v[236:237], v12 offset:18592
    ds_read_b64_tr_b16 v[238:239], v12 offset:19360
    v_cos_f32 v148, v146
    v_mfma_f32_16x16x32_bf16 v[184:187], v[208:211], v[120:123], v[184:187]
    v_cos_f32 v149, v147
    v_sin_f32 v150, v146
    v_mfma_f32_16x16x32_bf16 v[188:191], v[212:215], v[120:123], v[188:191]
    s_add_u32 m0, s55, 12288
    s_add_u32 s73, s47, 0
    buffer_load_dwordx4 v2, s[28:31], s73 offen sc1 lds
    s_waitcnt vmcnt(12) lgkmcnt(0)
    s_barrier
    v_sin_f32 v151, v147
    v_mfma_f32_16x16x32_bf16 v[168:171], v[216:219], v[124:127], v[168:171]
    ds_read_b64_tr_b16 v[192:193], v9 offset:0
    ds_read_b64_tr_b16 v[194:195], v9 offset:768
    ds_read_b64_tr_b16 v[196:197], v10 offset:32
    v_mul_f32 v148, v148, v40
    v_mfma_f32_16x16x32_bf16 v[172:175], v[220:223], v[124:127], v[172:175]
    buffer_load_dwordx4 v2, s[28:31], s73 offen offset:1024 sc1 lds
    ds_read_b64_tr_b16 v[198:199], v10 offset:800
    ds_read_b64_tr_b16 v[200:201], v9 offset:64
    ds_read_b64_tr_b16 v[202:203], v9 offset:832
    v_mfma_f32_16x16x32_bf16 v[176:179], v[224:227], v[124:127], v[176:179]
    ds_read_b64_tr_b16 v[204:205], v10 offset:96
    ds_read_b64_tr_b16 v[206:207], v10 offset:864
    ds_read_b64_tr_b16 v[208:209], v9 offset:128
    v_mul_f32 v149, v149, v40
    v_mfma_f32_16x16x32_bf16 v[180:183], v[228:231], v[124:127], v[180:183]
    ds_read_b64_tr_b16 v[210:211], v9 offset:896
    ds_read_b64_tr_b16 v[212:213], v10 offset:160
    buffer_load_dwordx4 v2, s[28:31], s73 offen offset:2048 sc1 lds
    ds_read_b64_tr_b16 v[214:215], v10 offset:928
    v_mfma_f32_16x16x32_bf16 v[184:187], v[232:235], v[124:127], v[184:187]
    v_mul_f32 v150, v150, v40
    v_mul_f32 v151, v151, v40
    v_cvt_pk_bf16_f32 v243, v148, v149
    v_cvt_pk_bf16_f32 v247, v150, v151
    v_mfma_f32_16x16x32_bf16 v[188:191], v[236:239], v[124:127], v[188:191]
    v_and_b32 v146, 1, v0
    v_sub_u32 v146, 0, v146
    v_and_b32 v248, v146, v240
    v_and_b32 v249, v146, v241
    s_waitcnt lgkmcnt(0)
    v_mfma_f32_16x16x32_bf16 v[168:171], v[192:195], v[128:131], v[168:171]
    buffer_load_dwordx4 v2, s[28:31], s73 offen offset:3072 sc1 lds
    ds_read_b64_tr_b16 v[216:217], v9 offset:6144
    ds_read_b64_tr_b16 v[218:219], v9 offset:6912
    ds_read_b64_tr_b16 v[220:221], v10 offset:6176
    v_mfma_f32_16x16x32_bf16 v[172:175], v[196:199], v[128:131], v[172:175]
    ds_read_b64_tr_b16 v[222:223], v10 offset:6944
    ds_read_b64_tr_b16 v[224:225], v9 offset:6208
    ds_read_b64_tr_b16 v[226:227], v9 offset:6976
    v_and_b32 v250, v146, v242
    v_mfma_f32_16x16x32_bf16 v[176:179], v[200:203], v[128:131], v[176:179]
    s_add_u32 m0, s55, 16384
    s_add_u32 s73, s47, 4096
    buffer_load_dwordx4 v2, s[28:31], s73 offen sc1 lds
    ds_read_b64_tr_b16 v[228:229], v10 offset:6240
    ds_read_b64_tr_b16 v[230:231], v10 offset:7008
    ds_read_b64_tr_b16 v[232:233], v9 offset:6272
    v_mfma_f32_16x16x32_bf16 v[180:183], v[204:207], v[128:131], v[180:183]
    ds_read_b64_tr_b16 v[234:235], v9 offset:7040
    ds_read_b64_tr_b16 v[236:237], v10 offset:6304
    ds_read_b64_tr_b16 v[238:239], v10 offset:7072
    v_and_b32 v251, v146, v243
    v_mfma_f32_16x16x32_bf16 v[184:187], v[208:211], v[128:131], v[184:187]
    v_and_b32 v252, v146, v244
    v_and_b32 v253, v146, v245
    v_and_b32 v254, v146, v246
    v_and_b32 v255, v146, v247
    v_mfma_f32_16x16x32_bf16 v[188:191], v[212:215], v[128:131], v[188:191]
    buffer_load_dwordx4 v2, s[28:31], s73 offen offset:1024 sc1 lds
    s_waitcnt vmcnt(14) lgkmcnt(0)
    s_barrier
    v_xor_b32 v240, v240, v248
    v_mfma_f32_16x16x32_bf16 v[168:171], v[216:219], v[132:135], v[168:171]
    ds_read_b64_tr_b16 v[192:193], v9 offset:12288
    ds_read_b64_tr_b16 v[194:195], v9 offset:13056
    ds_read_b64_tr_b16 v[196:197], v10 offset:12320
    v_xor_b32 v241, v241, v249
    v_mfma_f32_16x16x32_bf16 v[172:175], v[220:223], v[132:135], v[172:175]
    buffer_load_dwordx4 v2, s[28:31], s73 offen offset:2048 sc1 lds
    ds_read_b64_tr_b16 v[198:199], v10 offset:13088
    ds_read_b64_tr_b16 v[200:201], v9 offset:12352
    ds_read_b64_tr_b16 v[202:203], v9 offset:13120
    v_mfma_f32_16x16x32_bf16 v[176:179], v[224:227], v[132:135], v[176:179]
    ds_read_b64_tr_b16 v[204:205], v10 offset:12384
    ds_read_b64_tr_b16 v[206:207], v10 offset:13152
    ds_read_b64_tr_b16 v[208:209], v9 offset:12416
    v_xor_b32 v242, v242, v250
    v_mfma_f32_16x16x32_bf16 v[180:183], v[228:231], v[132:135], v[180:183]
    ds_read_b64_tr_b16 v[210:211], v9 offset:13184
    ds_read_b64_tr_b16 v[212:213], v10 offset:12448
    buffer_load_dwordx4 v2, s[28:31], s73 offen offset:3072 sc1 lds
    ds_read_b64_tr_b16 v[214:215], v10 offset:13216
    v_mfma_f32_16x16x32_bf16 v[184:187], v[232:235], v[132:135], v[184:187]
    v_xor_b32 v243, v243, v251
    v_xor_b32 v244, v244, v252
    v_xor_b32 v245, v245, v253
    v_xor_b32 v246, v246, v254
    v_mfma_f32_16x16x32_bf16 v[188:191], v[236:239], v[132:135], v[188:191]
    v_xor_b32 v247, v247, v255
    s_waitcnt lgkmcnt(0)
    v_mfma_f32_16x16x32_bf16 v[168:171], v[192:195], v[136:139], v[168:171]
    ds_read_b64_tr_b16 v[216:217], v9 offset:18432
    s_add_u32 m0, s55, 0
    s_add_u32 s73, s57, 0
    buffer_load_dwordx4 v2, s[28:31], s73 offen sc1 lds
    ds_read_b64_tr_b16 v[218:219], v9 offset:19200
    ds_read_b64_tr_b16 v[220:221], v10 offset:18464
    v_mfma_f32_16x16x32_bf16 v[172:175], v[196:199], v[136:139], v[172:175]
    ds_read_b64_tr_b16 v[222:223], v10 offset:19232
    ds_read_b64_tr_b16 v[224:225], v9 offset:18496
    ds_read_b64_tr_b16 v[226:227], v9 offset:19264
    v_mfma_f32_16x16x32_bf16 v[176:179], v[200:203], v[136:139], v[176:179]
    ds_read_b64_tr_b16 v[228:229], v10 offset:18528
    ds_read_b64_tr_b16 v[230:231], v10 offset:19296
    ds_read_b64_tr_b16 v[232:233], v9 offset:18560
    v_mfma_f32_16x16x32_bf16 v[180:183], v[204:207], v[136:139], v[180:183]
    buffer_load_dwordx4 v2, s[28:31], s73 offen offset:1024 sc1 lds
    ds_read_b64_tr_b16 v[234:235], v9 offset:19328
    ds_read_b64_tr_b16 v[236:237], v10 offset:18592
    ds_read_b64_tr_b16 v[238:239], v10 offset:19360
    v_mfma_f32_16x16x32_bf16 v[184:187], v[208:211], v[136:139], v[184:187]
    v_mfma_f32_16x16x32_bf16 v[188:191], v[212:215], v[136:139], v[188:191]
    s_waitcnt lgkmcnt(0)
    v_mfma_f32_16x16x32_bf16 v[168:171], v[216:219], v[140:143], v[168:171]
    buffer_load_dwordx4 v2, s[28:31], s73 offen offset:2048 sc1 lds
    v_mfma_f32_16x16x32_bf16 v[172:175], v[220:223], v[140:143], v[172:175]
    v_mfma_f32_16x16x32_bf16 v[176:179], v[224:227], v[140:143], v[176:179]
    v_mfma_f32_16x16x32_bf16 v[180:183], v[228:231], v[140:143], v[180:183]
    v_mfma_f32_16x16x32_bf16 v[184:187], v[232:235], v[140:143], v[184:187]
    v_mfma_f32_16x16x32_bf16 v[188:191], v[236:239], v[140:143], v[188:191]
    buffer_load_dwordx4 v2, s[28:31], s73 offen offset:3072 sc1 lds
    s_nop 0
    s_waitcnt vmcnt(16)
    ds_read_b64_tr_b16 v[64:65], v25 offset:4096
    ds_read_b64_tr_b16 v[66:67], v25 offset:5120
    ds_read_b64_tr_b16 v[68:69], v26 offset:4096
    ds_read_b64_tr_b16 v[70:71], v26 offset:5120
    ds_read_b64_tr_b16 v[72:73], v27 offset:4096
    ds_read_b64_tr_b16 v[74:75], v27 offset:5120
    ds_read_b64_tr_b16 v[76:77], v28 offset:4096
    ds_read_b64_tr_b16 v[78:79], v28 offset:5120
    s_waitcnt lgkmcnt(0)
    v_mfma_f32_16x16x32_bf16 v[96:99], v[64:67], a[0:3], 0
    v_mul_f32 v160, v168, v168
    v_mul_f32 v161, v169, v169
    v_mfma_f32_16x16x32_bf16 v[104:107], v[64:67], a[4:7], 0
    s_add_u32 m0, s55, 4096
    s_add_u32 s73, s57, 4096
    buffer_load_dwordx4 v2, s[28:31], s73 offen sc1 lds
    v_mfma_f32_16x16x32_bf16 v[112:115], v[64:67], a[8:11], 0
    v_mul_f32 v162, v170, v170
    v_mul_f32 v163, v171, v171
    v_mfma_f32_16x16x32_bf16 v[120:123], v[64:67], a[12:15], 0
    s_waitcnt vmcnt(13)
    ds_read_b64_tr_b16 v[80:81], v25 offset:8192
    v_mul_f32 v164, v172, v172
    v_mfma_f32_16x16x32_bf16 v[100:103], v[68:71], a[0:3], 0
    ds_read_b64_tr_b16 v[82:83], v25 offset:9216
    v_mul_f32 v165, v173, v173
    v_mfma_f32_16x16x32_bf16 v[108:111], v[68:71], a[4:7], 0
    ds_read_b64_tr_b16 v[84:85], v26 offset:8192
    buffer_load_dwordx4 v2, s[28:31], s73 offen offset:1024 sc1 lds
    v_mfma_f32_16x16x32_bf16 v[116:119], v[68:71], a[8:11], 0
    ds_read_b64_tr_b16 v[86:87], v26 offset:9216
    v_mul_f32 v166, v174, v174
    v_mfma_f32_16x16x32_bf16 v[124:127], v[68:71], a[12:15], 0
    ds_read_b64_tr_b16 v[88:89], v27 offset:8192
    v_mul_f32 v167, v175, v175
    v_mfma_f32_16x16x32_bf16 v[96:99], v[72:75], a[16:19], v[96:99]
    ds_read_b64_tr_b16 v[90:91], v27 offset:9216
    v_fma_f32 v160, v160, v21, v20
    v_mfma_f32_16x16x32_bf16 v[104:107], v[72:75], a[20:23], v[104:107]
    ds_read_b64_tr_b16 v[92:93], v28 offset:8192
    buffer_load_dwordx4 v2, s[28:31], s73 offen offset:2048 sc1 lds
    v_mfma_f32_16x16x32_bf16 v[112:115], v[72:75], a[24:27], v[112:115]
    ds_read_b64_tr_b16 v[94:95], v28 offset:9216
    v_fma_f32 v161, v161, v21, v20
    v_mfma_f32_16x16x32_bf16 v[120:123], v[72:75], a[28:31], v[120:123]
    v_fma_f32 v162, v162, v21, v20
    v_fma_f32 v163, v163, v21, v20
    v_mfma_f32_16x16x32_bf16 v[100:103], v[76:79], a[16:19], v[100:103]
    v_fma_f32 v164, v164, v21, v20
    v_fma_f32 v165, v165, v21, v20
    v_mfma_f32_16x16x32_bf16 v[108:111], v[76:79], a[20:23], v[108:111]
    buffer_load_dwordx4 v2, s[28:31], s73 offen offset:3072 sc1 lds
    v_mfma_f32_16x16x32_bf16 v[116:119], v[76:79], a[24:27], v[116:119]
    v_fma_f32 v166, v166, v21, v20
    v_fma_f32 v167, v167, v21, v20
    v_mfma_f32_16x16x32_bf16 v[124:127], v[76:79], a[28:31], v[124:127]
    v_mul_f32 v160, v160, v168
    v_mul_f32 v161, v161, v169
    s_waitcnt lgkmcnt(0)
    v_mfma_f32_16x16x32_bf16 v[96:99], v[80:83], a[32:35], v[96:99]
    v_mul_f32 v162, v162, v170
    v_mul_f32 v163, v163, v171
    v_mfma_f32_16x16x32_bf16 v[104:107], v[80:83], a[36:39], v[104:107]
    s_add_u32 m0, s55, 8192
    s_add_u32 s73, s66, 0
    buffer_load_dwordx4 v2, s[28:31], s73 offen sc1 lds
    v_mfma_f32_16x16x32_bf16 v[112:115], v[80:83], a[40:43], v[112:115]
    v_mul_f32 v164, v164, v172
    v_mul_f32 v165, v165, v173
    v_mfma_f32_16x16x32_bf16 v[120:123], v[80:83], a[44:47], v[120:123]
    s_waitcnt vmcnt(13)
    ds_read_b64_tr_b16 v[64:65], v25 offset:12288
    v_mul_f32 v166, v166, v174
    v_mfma_f32_16x16x32_bf16 v[100:103], v[84:87], a[32:35], v[100:103]
    ds_read_b64_tr_b16 v[66:67], v25 offset:13312
    v_mul_f32 v167, v167, v175
    v_mfma_f32_16x16x32_bf16 v[108:111], v[84:87], a[36:39], v[108:111]
    ds_read_b64_tr_b16 v[68:69], v26 offset:12288
    buffer_load_dwordx4 v2, s[28:31], s73 offen offset:1024 sc1 lds
    v_mfma_f32_16x16x32_bf16 v[116:119], v[84:87], a[40:43], v[116:119]
    ds_read_b64_tr_b16 v[70:71], v26 offset:13312
    v_mfma_f32_16x16x32_bf16 v[124:127], v[84:87], a[44:47], v[124:127]
    ds_read_b64_tr_b16 v[72:73], v27 offset:12288
    v_mfma_f32_16x16x32_bf16 v[96:99], v[88:91], a[48:51], v[96:99]
    ds_read_b64_tr_b16 v[74:75], v27 offset:13312
    v_mfma_f32_16x16x32_bf16 v[104:107], v[88:91], a[52:55], v[104:107]
    ds_read_b64_tr_b16 v[76:77], v28 offset:12288
    buffer_load_dwordx4 v2, s[28:31], s73 offen offset:2048 sc1 lds
    v_mfma_f32_16x16x32_bf16 v[112:115], v[88:91], a[56:59], v[112:115]
    ds_read_b64_tr_b16 v[78:79], v28 offset:13312
    v_mfma_f32_16x16x32_bf16 v[120:123], v[88:91], a[60:63], v[120:123]
    v_exp_f32 v160, v160
    v_mfma_f32_16x16x32_bf16 v[100:103], v[92:95], a[48:51], v[100:103]
    v_exp_f32 v161, v161
    v_mfma_f32_16x16x32_bf16 v[108:111], v[92:95], a[52:55], v[108:111]
    buffer_load_dwordx4 v2, s[28:31], s73 offen offset:3072 sc1 lds
    v_mfma_f32_16x16x32_bf16 v[116:119], v[92:95], a[56:59], v[116:119]
    v_exp_f32 v162, v162
    v_mfma_f32_16x16x32_bf16 v[124:127], v[92:95], a[60:63], v[124:127]
    v_exp_f32 v163, v163
    s_waitcnt lgkmcnt(0)
    v_mfma_f32_16x16x32_bf16 v[96:99], v[64:67], a[64:67], v[96:99]
    v_exp_f32 v164, v164
    v_mfma_f32_16x16x32_bf16 v[104:107], v[64:67], a[68:71], v[104:107]
    s_add_u32 m0, s55, 12288
    s_add_u32 s73, s66, 4096
    buffer_load_dwordx4 v2, s[28:31], s73 offen sc1 lds
    v_mfma_f32_16x16x32_bf16 v[112:115], v[64:67], a[72:75], v[112:115]
    v_exp_f32 v165, v165
    v_mfma_f32_16x16x32_bf16 v[120:123], v[64:67], a[76:79], v[120:123]
    s_waitcnt vmcnt(13)
    ds_read_b64_tr_b16 v[80:81], v25 offset:16384
    v_mfma_f32_16x16x32_bf16 v[100:103], v[68:71], a[64:67], v[100:103]
    ds_read_b64_tr_b16 v[82:83], v25 offset:17408
    v_mfma_f32_16x16x32_bf16 v[108:111], v[68:71], a[68:71], v[108:111]
    ds_read_b64_tr_b16 v[84:85], v26 offset:16384
    buffer_load_dwordx4 v2, s[28:31], s73 offen offset:1024 sc1 lds
    v_mfma_f32_16x16x32_bf16 v[116:119], v[68:71], a[72:75], v[116:119]
    ds_read_b64_tr_b16 v[86:87], v26 offset:17408
    v_mfma_f32_16x16x32_bf16 v[124:127], v[68:71], a[76:79], v[124:127]
    ds_read_b64_tr_b16 v[88:89], v27 offset:16384
    v_mfma_f32_16x16x32_bf16 v[96:99], v[72:75], a[80:83], v[96:99]
    ds_read_b64_tr_b16 v[90:91], v27 offset:17408
    v_mfma_f32_16x16x32_bf16 v[104:107], v[72:75], a[84:87], v[104:107]
    ds_read_b64_tr_b16 v[92:93], v28 offset:16384
    buffer_load_dwordx4 v2, s[28:31], s73 offen offset:2048 sc1 lds
    v_mfma_f32_16x16x32_bf16 v[112:115], v[72:75], a[88:91], v[112:115]
    ds_read_b64_tr_b16 v[94:95], v28 offset:17408
    v_mfma_f32_16x16x32_bf16 v[120:123], v[72:75], a[92:95], v[120:123]
    v_exp_f32 v166, v166
    v_mfma_f32_16x16x32_bf16 v[100:103], v[76:79], a[80:83], v[100:103]
    v_exp_f32 v167, v167
    v_mfma_f32_16x16x32_bf16 v[108:111], v[76:79], a[84:87], v[108:111]
    buffer_load_dwordx4 v2, s[28:31], s73 offen offset:3072 sc1 lds
    v_mfma_f32_16x16x32_bf16 v[116:119], v[76:79], a[88:91], v[116:119]
    v_add_f32 v160, 1.0, v160
    v_add_f32 v161, 1.0, v161
    v_mfma_f32_16x16x32_bf16 v[124:127], v[76:79], a[92:95], v[124:127]
    v_add_f32 v162, 1.0, v162
    v_add_f32 v163, 1.0, v163
    s_waitcnt lgkmcnt(0)
    v_mfma_f32_16x16x32_bf16 v[96:99], v[80:83], a[96:99], v[96:99]
    v_add_f32 v164, 1.0, v164
    v_add_f32 v165, 1.0, v165
    v_mfma_f32_16x16x32_bf16 v[104:107], v[80:83], a[100:103], v[104:107]
    s_add_u32 m0, s55, 16384
    s_add_u32 s73, s65, 131072
    buffer_load_dwordx4 v2, s[28:31], s73 offen sc1 lds
    v_mfma_f32_16x16x32_bf16 v[112:115], v[80:83], a[104:107], v[112:115]
    v_add_f32 v166, 1.0, v166
    v_add_f32 v167, 1.0, v167
    v_mfma_f32_16x16x32_bf16 v[120:123], v[80:83], a[108:111], v[120:123]
    s_waitcnt vmcnt(13)
    ds_read_b64_tr_b16 v[64:65], v25 offset:0
    v_mfma_f32_16x16x32_bf16 v[100:103], v[84:87], a[96:99], v[100:103]
    ds_read_b64_tr_b16 v[66:67], v25 offset:1024
    v_mfma_f32_16x16x32_bf16 v[108:111], v[84:87], a[100:103], v[108:111]
    ds_read_b64_tr_b16 v[68:69], v26 offset:0
    buffer_load_dwordx4 v2, s[28:31], s73 offen offset:1024 sc1 lds
    v_mfma_f32_16x16x32_bf16 v[116:119], v[84:87], a[104:107], v[116:119]
    ds_read_b64_tr_b16 v[70:71], v26 offset:1024
    v_mfma_f32_16x16x32_bf16 v[124:127], v[84:87], a[108:111], v[124:127]
    ds_read_b64_tr_b16 v[72:73], v27 offset:0
    v_mfma_f32_16x16x32_bf16 v[96:99], v[88:91], a[112:115], v[96:99]
    ds_read_b64_tr_b16 v[74:75], v27 offset:1024
    v_mfma_f32_16x16x32_bf16 v[104:107], v[88:91], a[116:119], v[104:107]
    ds_read_b64_tr_b16 v[76:77], v28 offset:0
    buffer_load_dwordx4 v2, s[28:31], s73 offen offset:2048 sc1 lds
    v_mfma_f32_16x16x32_bf16 v[112:115], v[88:91], a[120:123], v[112:115]
    ds_read_b64_tr_b16 v[78:79], v28 offset:1024
    v_mfma_f32_16x16x32_bf16 v[120:123], v[88:91], a[124:127], v[120:123]
    v_rcp_f32 v160, v160
    v_mfma_f32_16x16x32_bf16 v[100:103], v[92:95], a[112:115], v[100:103]
    v_rcp_f32 v161, v161
    v_mfma_f32_16x16x32_bf16 v[108:111], v[92:95], a[116:119], v[108:111]
    buffer_load_dwordx4 v2, s[28:31], s73 offen offset:3072 sc1 lds
    v_mfma_f32_16x16x32_bf16 v[116:119], v[92:95], a[120:123], v[116:119]
    v_rcp_f32 v162, v162
    v_mfma_f32_16x16x32_bf16 v[124:127], v[92:95], a[124:127], v[124:127]
    s_sub_u32 s76, 7, s49
    s_min_u32 s76, s76, s49
    s_lshl_b32 s76, s76, 1
    s_lshr_b32 s68, s49, 2
    s_xor_b32 s69, s68, s51
    s_add_u32 s76, s76, s69
    s_lshl_b32 s76, s76, 2
    s_lshr_b32 s69, s48, 3
    s_add_u32 s76, s76, s69
    s_lshl_b32 s76, s76, 7
    s_add_u32 s76, s76, 8192
    buffer_load_dword v4, v24, s[28:31], s76 offen sc1
    s_waitcnt lgkmcnt(0)
    v_mfma_f32_16x16x32_bf16 v[96:99], v[64:67], a[128:131], v[96:99]
    v_rcp_f32 v163, v163
    v_mfma_f32_16x16x32_bf16 v[104:107], v[64:67], a[132:135], v[104:107]
    s_add_u32 m0, s55, 0
    s_add_u32 s73, s65, 135168
    buffer_load_dwordx4 v2, s[28:31], s73 offen sc1 lds
    v_mfma_f32_16x16x32_bf16 v[112:115], v[64:67], a[136:139], v[112:115]
    v_rcp_f32 v164, v164
    v_mfma_f32_16x16x32_bf16 v[120:123], v[64:67], a[140:143], v[120:123]
    s_waitcnt vmcnt(14)
    ds_read_b64_tr_b16 v[80:81], v25 offset:4096
    v_mfma_f32_16x16x32_bf16 v[100:103], v[68:71], a[128:131], v[100:103]
    ds_read_b64_tr_b16 v[82:83], v25 offset:5120
    v_mfma_f32_16x16x32_bf16 v[108:111], v[68:71], a[132:135], v[108:111]
    ds_read_b64_tr_b16 v[84:85], v26 offset:4096
    buffer_load_dwordx4 v2, s[28:31], s73 offen offset:1024 sc1 lds
    v_mfma_f32_16x16x32_bf16 v[116:119], v[68:71], a[136:139], v[116:119]
    ds_read_b64_tr_b16 v[86:87], v26 offset:5120
    v_mfma_f32_16x16x32_bf16 v[124:127], v[68:71], a[140:143], v[124:127]
    ds_read_b64_tr_b16 v[88:89], v27 offset:4096
    v_mfma_f32_16x16x32_bf16 v[96:99], v[72:75], a[144:147], v[96:99]
    ds_read_b64_tr_b16 v[90:91], v27 offset:5120
    v_mfma_f32_16x16x32_bf16 v[104:107], v[72:75], a[148:151], v[104:107]
    ds_read_b64_tr_b16 v[92:93], v28 offset:4096
    buffer_load_dwordx4 v2, s[28:31], s73 offen offset:2048 sc1 lds
    v_mfma_f32_16x16x32_bf16 v[112:115], v[72:75], a[152:155], v[112:115]
    ds_read_b64_tr_b16 v[94:95], v28 offset:5120
    v_mfma_f32_16x16x32_bf16 v[120:123], v[72:75], a[156:159], v[120:123]
    v_rcp_f32 v165, v165
    v_mfma_f32_16x16x32_bf16 v[100:103], v[76:79], a[144:147], v[100:103]
    v_rcp_f32 v166, v166
    v_mfma_f32_16x16x32_bf16 v[108:111], v[76:79], a[148:151], v[108:111]
    buffer_load_dwordx4 v2, s[28:31], s73 offen offset:3072 sc1 lds
    v_mfma_f32_16x16x32_bf16 v[116:119], v[76:79], a[152:155], v[116:119]
    v_rcp_f32 v167, v167
    v_mfma_f32_16x16x32_bf16 v[124:127], v[76:79], a[156:159], v[124:127]
    v_mul_f32 v168, v168, v160
    v_mul_f32 v169, v169, v161
    s_waitcnt lgkmcnt(0)
    v_mfma_f32_16x16x32_bf16 v[96:99], v[80:83], a[160:163], v[96:99]
    v_mul_f32 v170, v170, v162
    v_mul_f32 v171, v171, v163
    v_mfma_f32_16x16x32_bf16 v[104:107], v[80:83], a[164:167], v[104:107]
    s_add_u32 m0, s55, 4096
    s_add_u32 s73, s47, 131072
    buffer_load_dwordx4 v2, s[28:31], s73 offen sc1 lds
    v_mfma_f32_16x16x32_bf16 v[112:115], v[80:83], a[168:171], v[112:115]
    v_mul_f32 v172, v172, v164
    v_mul_f32 v173, v173, v165
    v_mfma_f32_16x16x32_bf16 v[120:123], v[80:83], a[172:175], v[120:123]
    s_waitcnt vmcnt(14)
    ds_read_b64_tr_b16 v[64:65], v25 offset:8192
    v_mul_f32 v174, v174, v166
    v_mfma_f32_16x16x32_bf16 v[100:103], v[84:87], a[160:163], v[100:103]
    ds_read_b64_tr_b16 v[66:67], v25 offset:9216
    v_mul_f32 v175, v175, v167
    v_mfma_f32_16x16x32_bf16 v[108:111], v[84:87], a[164:167], v[108:111]
    ds_read_b64_tr_b16 v[68:69], v26 offset:8192
    buffer_load_dwordx4 v2, s[28:31], s73 offen offset:1024 sc1 lds
    v_mfma_f32_16x16x32_bf16 v[116:119], v[84:87], a[168:171], v[116:119]
    ds_read_b64_tr_b16 v[70:71], v26 offset:9216
    v_mul_f32 v168, v168, v41
    v_mfma_f32_16x16x32_bf16 v[124:127], v[84:87], a[172:175], v[124:127]
    ds_read_b64_tr_b16 v[72:73], v27 offset:8192
    v_mul_f32 v169, v169, v41
    v_mfma_f32_16x16x32_bf16 v[96:99], v[88:91], a[176:179], v[96:99]
    ds_read_b64_tr_b16 v[74:75], v27 offset:9216
    v_mul_f32 v170, v170, v41
    v_mfma_f32_16x16x32_bf16 v[104:107], v[88:91], a[180:183], v[104:107]
    ds_read_b64_tr_b16 v[76:77], v28 offset:8192
    buffer_load_dwordx4 v2, s[28:31], s73 offen offset:2048 sc1 lds
    v_mfma_f32_16x16x32_bf16 v[112:115], v[88:91], a[184:187], v[112:115]
    ds_read_b64_tr_b16 v[78:79], v28 offset:9216
    v_mul_f32 v171, v171, v41
    v_mfma_f32_16x16x32_bf16 v[120:123], v[88:91], a[188:191], v[120:123]
    v_mul_f32 v172, v172, v41
    v_mul_f32 v173, v173, v41
    v_mfma_f32_16x16x32_bf16 v[100:103], v[92:95], a[176:179], v[100:103]
    v_mul_f32 v174, v174, v41
    v_mul_f32 v175, v175, v41
    v_mfma_f32_16x16x32_bf16 v[108:111], v[92:95], a[180:183], v[108:111]
    buffer_load_dwordx4 v2, s[28:31], s73 offen offset:3072 sc1 lds
    v_mfma_f32_16x16x32_bf16 v[116:119], v[92:95], a[184:187], v[116:119]
    v_mul_f32 v160, v176, v176
    v_mul_f32 v161, v177, v177
    v_mfma_f32_16x16x32_bf16 v[124:127], v[92:95], a[188:191], v[124:127]
    v_mul_f32 v162, v178, v178
    v_mul_f32 v163, v179, v179
    s_waitcnt lgkmcnt(0)
    v_mfma_f32_16x16x32_bf16 v[96:99], v[64:67], a[192:195], v[96:99]
    v_mul_f32 v164, v180, v180
    v_mul_f32 v165, v181, v181
    v_mfma_f32_16x16x32_bf16 v[104:107], v[64:67], a[196:199], v[104:107]
    s_add_u32 m0, s55, 8192
    s_add_u32 s73, s47, 135168
    buffer_load_dwordx4 v2, s[28:31], s73 offen sc1 lds
    v_mfma_f32_16x16x32_bf16 v[112:115], v[64:67], a[200:203], v[112:115]
    v_mul_f32 v166, v182, v182
    v_mul_f32 v167, v183, v183
    v_mfma_f32_16x16x32_bf16 v[120:123], v[64:67], a[204:207], v[120:123]
    s_waitcnt vmcnt(14)
    ds_read_b64_tr_b16 v[80:81], v25 offset:12288
    v_fma_f32 v160, v160, v21, v20
    v_mfma_f32_16x16x32_bf16 v[100:103], v[68:71], a[192:195], v[100:103]
    ds_read_b64_tr_b16 v[82:83], v25 offset:13312
    v_fma_f32 v161, v161, v21, v20
    v_mfma_f32_16x16x32_bf16 v[108:111], v[68:71], a[196:199], v[108:111]
    ds_read_b64_tr_b16 v[84:85], v26 offset:12288
    buffer_load_dwordx4 v2, s[28:31], s73 offen offset:1024 sc1 lds
    v_mfma_f32_16x16x32_bf16 v[116:119], v[68:71], a[200:203], v[116:119]
    ds_read_b64_tr_b16 v[86:87], v26 offset:13312
    v_fma_f32 v162, v162, v21, v20
    v_mfma_f32_16x16x32_bf16 v[124:127], v[68:71], a[204:207], v[124:127]
    ds_read_b64_tr_b16 v[88:89], v27 offset:12288
    v_fma_f32 v163, v163, v21, v20
    v_mfma_f32_16x16x32_bf16 v[96:99], v[72:75], a[208:211], v[96:99]
    ds_read_b64_tr_b16 v[90:91], v27 offset:13312
    v_fma_f32 v164, v164, v21, v20
    v_mfma_f32_16x16x32_bf16 v[104:107], v[72:75], a[212:215], v[104:107]
    ds_read_b64_tr_b16 v[92:93], v28 offset:12288
    buffer_load_dwordx4 v2, s[28:31], s73 offen offset:2048 sc1 lds
    v_mfma_f32_16x16x32_bf16 v[112:115], v[72:75], a[216:219], v[112:115]
    ds_read_b64_tr_b16 v[94:95], v28 offset:13312
    v_fma_f32 v165, v165, v21, v20
    v_mfma_f32_16x16x32_bf16 v[120:123], v[72:75], a[220:223], v[120:123]
    v_fma_f32 v166, v166, v21, v20
    v_fma_f32 v167, v167, v21, v20
    v_mfma_f32_16x16x32_bf16 v[100:103], v[76:79], a[208:211], v[100:103]
    v_mul_f32 v160, v160, v176
    v_mul_f32 v161, v161, v177
    v_mfma_f32_16x16x32_bf16 v[108:111], v[76:79], a[212:215], v[108:111]
    buffer_load_dwordx4 v2, s[28:31], s73 offen offset:3072 sc1 lds
    v_mfma_f32_16x16x32_bf16 v[116:119], v[76:79], a[216:219], v[116:119]
    v_mul_f32 v162, v162, v178
    v_mul_f32 v163, v163, v179
    v_mfma_f32_16x16x32_bf16 v[124:127], v[76:79], a[220:223], v[124:127]
    s_waitcnt vmcnt(12)
    v_cmp_ne_u32 vcc, s53, v4
    s_nop 0
    s_cbranch_vccnz L_slow2
L_back2:
    s_waitcnt lgkmcnt(0)
    v_mfma_f32_16x16x32_bf16 v[96:99], v[80:83], a[224:227], v[96:99]
    v_mul_f32 v164, v164, v180
    v_mul_f32 v165, v165, v181
    v_mfma_f32_16x16x32_bf16 v[104:107], v[80:83], a[228:231], v[104:107]
    s_add_u32 m0, s55, 12288
    s_add_u32 s73, s57, 131072
    buffer_load_dwordx4 v2, s[28:31], s73 offen sc1 lds
    s_lshl_b32 s77, s49, 5
    s_add_u32 s77, s77, s48
    s_mul_i32 s77, s77, 20736
    s_mul_i32 s81, s50, 5120
    s_add_u32 s77, s77, s81
    s_add_u32 s77, s77, 8388608
    v_mfma_f32_16x16x32_bf16 v[112:115], v[80:83], a[232:235], v[112:115]
    v_mul_f32 v166, v166, v182
    v_mul_f32 v167, v167, v183
    v_mfma_f32_16x16x32_bf16 v[120:123], v[80:83], a[236:239], v[120:123]
    ds_read_b64_tr_b16 v[64:65], v25 offset:16384
    v_mfma_f32_16x16x32_bf16 v[100:103], v[84:87], a[224:227], v[100:103]
    ds_read_b64_tr_b16 v[66:67], v25 offset:17408
    v_mfma_f32_16x16x32_bf16 v[108:111], v[84:87], a[228:231], v[108:111]
    ds_read_b64_tr_b16 v[68:69], v26 offset:16384
    buffer_load_dwordx4 v2, s[28:31], s73 offen offset:1024 sc1 lds
    s_add_u32 m0, s81, 114688
    s_add_u32 s74, s77, 0
    buffer_load_dwordx4 v2, s[28:31], s74 offen sc1 lds
    v_mfma_f32_16x16x32_bf16 v[116:119], v[84:87], a[232:235], v[116:119]
    ds_read_b64_tr_b16 v[70:71], v26 offset:17408
    v_mfma_f32_16x16x32_bf16 v[124:127], v[84:87], a[236:239], v[124:127]
    ds_read_b64_tr_b16 v[72:73], v27 offset:16384
    v_mfma_f32_16x16x32_bf16 v[96:99], v[88:91], a[240:243], v[96:99]
    ds_read_b64_tr_b16 v[74:75], v27 offset:17408
    v_mfma_f32_16x16x32_bf16 v[104:107], v[88:91], a[244:247], v[104:107]
    s_add_u32 m0, s55, 12288
    ds_read_b64_tr_b16 v[76:77], v28 offset:16384
    buffer_load_dwordx4 v2, s[28:31], s73 offen offset:2048 sc1 lds
    s_add_u32 m0, s81, 114688
    s_nop 0
    buffer_load_dwordx4 v2, s[28:31], s74 offen offset:1024 sc1 lds
    v_mfma_f32_16x16x32_bf16 v[112:115], v[88:91], a[248:251], v[112:115]
    ds_read_b64_tr_b16 v[78:79], v28 offset:17408
    v_mfma_f32_16x16x32_bf16 v[120:123], v[88:91], a[252:255], v[120:123]
    v_exp_f32 v160, v160
    v_mfma_f32_16x16x32_bf16 v[100:103], v[92:95], a[240:243], v[100:103]
    v_exp_f32 v161, v161
    s_add_u32 m0, s55, 12288
    v_mfma_f32_16x16x32_bf16 v[108:111], v[92:95], a[244:247], v[108:111]
    buffer_load_dwordx4 v2, s[28:31], s73 offen offset:3072 sc1 lds
    s_add_u32 m0, s81, 114688
    s_nop 0
    buffer_load_dwordx4 v2, s[28:31], s74 offen offset:2048 sc1 lds
    v_mfma_f32_16x16x32_bf16 v[116:119], v[92:95], a[248:251], v[116:119]
    v_exp_f32 v162, v162
    v_mfma_f32_16x16x32_bf16 v[124:127], v[92:95], a[252:255], v[124:127]
    v_exp_f32 v163, v163
    s_waitcnt lgkmcnt(0)
    v_mfma_f32_16x16x32_bf16 v[128:131], v[64:67], a[0:3], 0
    v_exp_f32 v164, v164
    v_mfma_f32_16x16x32_bf16 v[136:139], v[64:67], a[4:7], 0
    buffer_load_dwordx4 v2, s[28:31], s74 offen offset:3072 sc1 lds
    v_mfma_f32_16x16x32_bf16 v[144:147], v[64:67], a[8:11], 0
    v_exp_f32 v165, v165
    v_mfma_f32_16x16x32_bf16 v[152:155], v[64:67], a[12:15], 0
    s_waitcnt vmcnt(16)
    ds_read_b64_tr_b16 v[80:81], v25 offset:0
    s_barrier
    v_mfma_f32_16x16x32_bf16 v[132:135], v[68:71], a[0:3], 0
    ds_read_b64_tr_b16 v[82:83], v25 offset:1024
    v_mfma_f32_16x16x32_bf16 v[140:143], v[68:71], a[4:7], 0
    ds_read_b64_tr_b16 v[84:85], v26 offset:0
    ds_write_b128 v30, v[104:107] offset:0
    ds_write_b128 v30, v[108:111] offset:1024
    s_add_u32 m0, s81, 118784
    s_add_u32 s74, s77, 4096
    buffer_load_dwordx4 v2, s[28:31], s74 offen sc1 lds
    v_mfma_f32_16x16x32_bf16 v[148:151], v[68:71], a[8:11], 0
    ds_read_b64_tr_b16 v[86:87], v26 offset:1024
    v_mfma_f32_16x16x32_bf16 v[156:159], v[68:71], a[12:15], 0
    ds_read_b64_tr_b16 v[88:89], v27 offset:0
    ds_write_b128 v31, v[112:115] offset:0
    ds_write_b128 v31, v[116:119] offset:1024
    v_mfma_f32_16x16x32_bf16 v[128:131], v[72:75], a[16:19], v[128:131]
    ds_read_b64_tr_b16 v[90:91], v27 offset:1024
    v_mfma_f32_16x16x32_bf16 v[136:139], v[72:75], a[20:23], v[136:139]
    ds_read_b64_tr_b16 v[92:93], v28 offset:0
    ds_write_b128 v32, v[120:123] offset:0
    ds_write_b128 v32, v[124:127] offset:1024
    v_mfma_f32_16x16x32_bf16 v[144:147], v[72:75], a[24:27], v[144:147]
    ds_read_b64_tr_b16 v[94:95], v28 offset:1024
    v_mfma_f32_16x16x32_bf16 v[152:155], v[72:75], a[28:31], v[152:155]
    v_exp_f32 v166, v166
    v_mfma_f32_16x16x32_bf16 v[132:135], v[76:79], a[16:19], v[132:135]
    v_exp_f32 v167, v167
    v_mfma_f32_16x16x32_bf16 v[140:143], v[76:79], a[20:23], v[140:143]
    v_add_f32 v160, 1.0, v160
    v_add_f32 v161, 1.0, v161
    v_mfma_f32_16x16x32_bf16 v[148:151], v[76:79], a[24:27], v[148:151]
    v_add_f32 v162, 1.0, v162
    v_add_f32 v163, 1.0, v163
    v_mfma_f32_16x16x32_bf16 v[156:159], v[76:79], a[28:31], v[156:159]
    s_add_u32 m0, s55, 16384
    s_add_u32 s73, s57, 135168
    buffer_load_dwordx4 v2, s[28:31], s73 offen sc1 lds
    buffer_load_dwordx4 v2, s[28:31], s73 offen offset:1024 sc1 lds
    buffer_load_dwordx4 v2, s[28:31], s73 offen offset:2048 sc1 lds
    buffer_load_dwordx4 v2, s[28:31], s73 offen offset:3072 sc1 lds
    s_waitcnt lgkmcnt(0)
    v_mfma_f32_16x16x32_bf16 v[128:131], v[80:83], a[32:35], v[128:131]
    v_add_f32 v164, 1.0, v164
    v_add_f32 v165, 1.0, v165
    v_mfma_f32_16x16x32_bf16 v[136:139], v[80:83], a[36:39], v[136:139]
    s_add_u32 m0, s55, 0
    s_add_u32 s73, s66, 131072
    buffer_load_dwordx4 v2, s[28:31], s73 offen sc1 lds
    v_mfma_f32_16x16x32_bf16 v[144:147], v[80:83], a[40:43], v[144:147]
    v_add_f32 v166, 1.0, v166
    v_add_f32 v167, 1.0, v167
    v_mfma_f32_16x16x32_bf16 v[152:155], v[80:83], a[44:47], v[152:155]
    s_waitcnt vmcnt(18)
    ds_read_b64_tr_b16 v[64:65], v25 offset:4096
    s_waitcnt vmcnt(5)
    s_barrier
    ds_read_b128 v[104:107], v29 offset:0
    ds_read_b128 v[108:111], v29 offset:1024
    ds_read_b128 v[112:115], v29 offset:2048
    v_mfma_f32_16x16x32_bf16 v[132:135], v[84:87], a[32:35], v[132:135]
    ds_read_b64_tr_b16 v[66:67], v25 offset:5120
    v_mfma_f32_16x16x32_bf16 v[140:143], v[84:87], a[36:39], v[140:143]
    ds_read_b64_tr_b16 v[68:69], v26 offset:4096
    buffer_load_dwordx4 v2, s[28:31], s73 offen offset:1024 sc1 lds
    ds_read_b128 v[116:119], v29 offset:3072
    ds_read_b128 v[120:123], v29 offset:4096
    ds_read_b128 v[124:127], v29 offset:5120
    v_mfma_f32_16x16x32_bf16 v[148:151], v[84:87], a[40:43], v[148:151]
    ds_read_b64_tr_b16 v[70:71], v26 offset:5120
    v_mfma_f32_16x16x32_bf16 v[156:159], v[84:87], a[44:47], v[156:159]
    ds_read_b64_tr_b16 v[72:73], v27 offset:4096
    v_pk_add_f32 v[96:97], v[96:97], v[22:23] op_sel_hi:[1,0]
    v_pk_add_f32 v[98:99], v[98:99], v[22:23] op_sel_hi:[1,0]
    v_pk_add_f32 v[100:101], v[100:101], v[22:23] op_sel_hi:[1,0]
    s_nop 0
    v_mfma_f32_16x16x32_bf16 v[128:131], v[88:91], a[48:51], v[128:131]
    ds_read_b64_tr_b16 v[74:75], v27 offset:5120
    v_mfma_f32_16x16x32_bf16 v[136:139], v[88:91], a[52:55], v[136:139]
    ds_read_b64_tr_b16 v[76:77], v28 offset:4096
    buffer_load_dwordx4 v2, s[28:31], s73 offen offset:2048 sc1 lds
    v_pk_add_f32 v[102:103], v[102:103], v[22:23] op_sel_hi:[1,0]
    s_waitcnt lgkmcnt(11)
    v_pk_add_f32 v[96:97], v[96:97], v[104:105]
    v_pk_add_f32 v[98:99], v[98:99], v[106:107]
    s_nop 0
    v_mfma_f32_16x16x32_bf16 v[144:147], v[88:91], a[56:59], v[144:147]
    ds_read_b64_tr_b16 v[78:79], v28 offset:5120
    v_mfma_f32_16x16x32_bf16 v[152:155], v[88:91], a[60:63], v[152:155]
    s_waitcnt lgkmcnt(11)
    v_pk_add_f32 v[100:101], v[100:101], v[108:109]
    v_pk_add_f32 v[102:103], v[102:103], v[110:111]
    s_waitcnt lgkmcnt(6)
    v_pk_add_f32 v[112:113], v[112:113], v[120:121]
    s_nop 0
    v_mfma_f32_16x16x32_bf16 v[132:135], v[92:95], a[48:51], v[132:135]
    v_rcp_f32 v160, v160
    v_mfma_f32_16x16x32_bf16 v[140:143], v[92:95], a[52:55], v[140:143]
    buffer_load_dwordx4 v2, s[28:31], s73 offen offset:3072 sc1 lds
    v_pk_add_f32 v[114:115], v[114:115], v[122:123]
    s_waitcnt lgkmcnt(5)
    v_pk_add_f32 v[116:117], v[116:117], v[124:125]
    v_pk_add_f32 v[118:119], v[118:119], v[126:127]
    s_nop 0
    v_mfma_f32_16x16x32_bf16 v[148:151], v[92:95], a[56:59], v[148:151]
    v_rcp_f32 v161, v161
    v_mfma_f32_16x16x32_bf16 v[156:159], v[92:95], a[60:63], v[156:159]
    v_pk_add_f32 v[96:97], v[96:97], v[112:113]
    v_pk_add_f32 v[98:99], v[98:99], v[114:115]
    v_pk_add_f32 v[100:101], v[100:101], v[116:117]
    s_nop 0
    v_mfma_f32_16x16x32_bf16 v[128:131], v[64:67], a[64:67], v[128:131]
    v_rcp_f32 v162, v162
    v_mfma_f32_16x16x32_bf16 v[136:139], v[64:67], a[68:71], v[136:139]
    s_add_u32 m0, s55, 4096
    s_add_u32 s73, s66, 135168
    s_waitcnt lgkmcnt(0)
    buffer_load_dwordx4 v2, s[28:31], s73 offen sc1 lds
    v_pk_add_f32 v[102:103], v[102:103], v[118:119]
    v_pk_mul_f32 v[96:97], v[96:97], v[168:169]
    v_pk_mul_f32 v[98:99], v[98:99], v[170:171]
    s_nop 0
    v_mfma_f32_16x16x32_bf16 v[144:147], v[64:67], a[72:75], v[144:147]
    v_rcp_f32 v163, v163
    v_mfma_f32_16x16x32_bf16 v[152:155], v[64:67], a[76:79], v[152:155]
    ds_read_b64_tr_b16 v[80:81], v25 offset:8192
    v_pk_mul_f32 v[100:101], v[100:101], v[172:173]
    v_pk_mul_f32 v[102:103], v[102:103], v[174:175]
    v_cvt_pk_bf16_f32 v104, v96, v97
    v_mfma_f32_16x16x32_bf16 v[132:135], v[68:71], a[64:67], v[132:135]
    ds_read_b64_tr_b16 v[82:83], v25 offset:9216
    v_mfma_f32_16x16x32_bf16 v[140:143], v[68:71], a[68:71], v[140:143]
    ds_read_b64_tr_b16 v[84:85], v26 offset:8192
    buffer_load_dwordx4 v2, s[28:31], s73 offen offset:1024 sc1 lds
    v_cvt_pk_bf16_f32 v105, v98, v99
    v_cvt_pk_bf16_f32 v106, v100, v101
    v_cvt_pk_bf16_f32 v107, v102, v103
    v_mfma_f32_16x16x32_bf16 v[148:151], v[68:71], a[72:75], v[148:151]
    ds_read_b64_tr_b16 v[86:87], v26 offset:9216
    v_mfma_f32_16x16x32_bf16 v[156:159], v[68:71], a[76:79], v[156:159]
    ds_read_b64_tr_b16 v[88:89], v27 offset:8192
    s_add_u32 s68, s85, 0
    buffer_store_dwordx4 v[104:107], v2, s[28:31], s68 offen sc1
    v_mfma_f32_16x16x32_bf16 v[128:131], v[72:75], a[80:83], v[128:131]
    ds_read_b64_tr_b16 v[90:91], v27 offset:9216
    v_mfma_f32_16x16x32_bf16 v[136:139], v[72:75], a[84:87], v[136:139]
    ds_read_b64_tr_b16 v[92:93], v28 offset:8192
    buffer_load_dwordx4 v2, s[28:31], s73 offen offset:2048 sc1 lds
    v_mfma_f32_16x16x32_bf16 v[144:147], v[72:75], a[88:91], v[144:147]
    ds_read_b64_tr_b16 v[94:95], v28 offset:9216
    v_mfma_f32_16x16x32_bf16 v[152:155], v[72:75], a[92:95], v[152:155]
    v_rcp_f32 v164, v164
    v_mfma_f32_16x16x32_bf16 v[132:135], v[76:79], a[80:83], v[132:135]
    v_rcp_f32 v165, v165
    v_mfma_f32_16x16x32_bf16 v[140:143], v[76:79], a[84:87], v[140:143]
    buffer_load_dwordx4 v2, s[28:31], s73 offen offset:3072 sc1 lds
    v_mfma_f32_16x16x32_bf16 v[148:151], v[76:79], a[88:91], v[148:151]
    v_rcp_f32 v166, v166
    v_mfma_f32_16x16x32_bf16 v[156:159], v[76:79], a[92:95], v[156:159]
    v_rcp_f32 v167, v167
    s_waitcnt lgkmcnt(0)
    v_mfma_f32_16x16x32_bf16 v[128:131], v[80:83], a[96:99], v[128:131]
    v_mul_f32 v176, v176, v160
    v_mul_f32 v177, v177, v161
    v_mfma_f32_16x16x32_bf16 v[136:139], v[80:83], a[100:103], v[136:139]
    s_add_u32 m0, s55, 8192
    s_add_u32 s73, s65, 262144
    buffer_load_dwordx4 v2, s[28:31], s73 offen sc1 lds
    v_mfma_f32_16x16x32_bf16 v[144:147], v[80:83], a[104:107], v[144:147]
    v_mul_f32 v178, v178, v162
    v_mul_f32 v179, v179, v163
    v_mfma_f32_16x16x32_bf16 v[152:155], v[80:83], a[108:111], v[152:155]
    ds_read_b64_tr_b16 v[64:65], v25 offset:12288
    v_mul_f32 v180, v180, v164
    v_mfma_f32_16x16x32_bf16 v[132:135], v[84:87], a[96:99], v[132:135]
    ds_read_b64_tr_b16 v[66:67], v25 offset:13312
    v_mul_f32 v181, v181, v165
    v_mfma_f32_16x16x32_bf16 v[140:143], v[84:87], a[100:103], v[140:143]
    ds_read_b64_tr_b16 v[68:69], v26 offset:12288
    buffer_load_dwordx4 v2, s[28:31], s73 offen offset:1024 sc1 lds
    v_mfma_f32_16x16x32_bf16 v[148:151], v[84:87], a[104:107], v[148:151]
    ds_read_b64_tr_b16 v[70:71], v26 offset:13312
    v_mul_f32 v182, v182, v166
    v_mfma_f32_16x16x32_bf16 v[156:159], v[84:87], a[108:111], v[156:159]
    ds_read_b64_tr_b16 v[72:73], v27 offset:12288
    v_mul_f32 v183, v183, v167
    v_mfma_f32_16x16x32_bf16 v[128:131], v[88:91], a[112:115], v[128:131]
    ds_read_b64_tr_b16 v[74:75], v27 offset:13312
    v_mul_f32 v176, v176, v41
    v_mfma_f32_16x16x32_bf16 v[136:139], v[88:91], a[116:119], v[136:139]
    ds_read_b64_tr_b16 v[76:77], v28 offset:12288
    buffer_load_dwordx4 v2, s[28:31], s73 offen offset:2048 sc1 lds
    v_mfma_f32_16x16x32_bf16 v[144:147], v[88:91], a[120:123], v[144:147]
    ds_read_b64_tr_b16 v[78:79], v28 offset:13312
    v_mul_f32 v177, v177, v41
    v_mfma_f32_16x16x32_bf16 v[152:155], v[88:91], a[124:127], v[152:155]
    v_mul_f32 v178, v178, v41
    v_mul_f32 v179, v179, v41
    v_mfma_f32_16x16x32_bf16 v[132:135], v[92:95], a[112:115], v[132:135]
    v_mul_f32 v180, v180, v41
    v_mul_f32 v181, v181, v41
    v_mfma_f32_16x16x32_bf16 v[140:143], v[92:95], a[116:119], v[140:143]
    buffer_load_dwordx4 v2, s[28:31], s73 offen offset:3072 sc1 lds
    v_mfma_f32_16x16x32_bf16 v[148:151], v[92:95], a[120:123], v[148:151]
    v_mul_f32 v182, v182, v41
    v_mul_f32 v183, v183, v41
    v_mfma_f32_16x16x32_bf16 v[156:159], v[92:95], a[124:127], v[156:159]
    v_mul_f32 v160, v184, v184
    v_mul_f32 v161, v185, v185
    s_waitcnt lgkmcnt(0)
    v_mfma_f32_16x16x32_bf16 v[128:131], v[64:67], a[128:131], v[128:131]
    v_mul_f32 v162, v186, v186
    v_mul_f32 v163, v187, v187
    v_mfma_f32_16x16x32_bf16 v[136:139], v[64:67], a[132:135], v[136:139]
    s_add_u32 m0, s55, 12288
    s_add_u32 s73, s65, 266240
    buffer_load_dwordx4 v2, s[28:31], s73 offen sc1 lds
    v_mfma_f32_16x16x32_bf16 v[144:147], v[64:67], a[136:139], v[144:147]
    v_mul_f32 v164, v188, v188
    v_mul_f32 v165, v189, v189
    v_mfma_f32_16x16x32_bf16 v[152:155], v[64:67], a[140:143], v[152:155]
    s_waitcnt vmcnt(14)
    ds_read_b64_tr_b16 v[80:81], v25 offset:16384
    v_mul_f32 v166, v190, v190
    v_mfma_f32_16x16x32_bf16 v[132:135], v[68:71], a[128:131], v[132:135]
    ds_read_b64_tr_b16 v[82:83], v25 offset:17408
    v_mul_f32 v167, v191, v191
    v_mfma_f32_16x16x32_bf16 v[140:143], v[68:71], a[132:135], v[140:143]
    ds_read_b64_tr_b16 v[84:85], v26 offset:16384
    buffer_load_dwordx4 v2, s[28:31], s73 offen offset:1024 sc1 lds
    v_mfma_f32_16x16x32_bf16 v[148:151], v[68:71], a[136:139], v[148:151]
    ds_read_b64_tr_b16 v[86:87], v26 offset:17408
    v_fma_f32 v160, v160, v21, v20
    v_mfma_f32_16x16x32_bf16 v[156:159], v[68:71], a[140:143], v[156:159]
    ds_read_b64_tr_b16 v[88:89], v27 offset:16384
    v_fma_f32 v161, v161, v21, v20
    v_mfma_f32_16x16x32_bf16 v[128:131], v[72:75], a[144:147], v[128:131]
    ds_read_b64_tr_b16 v[90:91], v27 offset:17408
    v_fma_f32 v162, v162, v21, v20
    v_mfma_f32_16x16x32_bf16 v[136:139], v[72:75], a[148:151], v[136:139]
    ds_read_b64_tr_b16 v[92:93], v28 offset:16384
    buffer_load_dwordx4 v2, s[28:31], s73 offen offset:2048 sc1 lds
    v_mfma_f32_16x16x32_bf16 v[144:147], v[72:75], a[152:155], v[144:147]
    ds_read_b64_tr_b16 v[94:95], v28 offset:17408
    v_fma_f32 v163, v163, v21, v20
    v_mfma_f32_16x16x32_bf16 v[152:155], v[72:75], a[156:159], v[152:155]
    v_fma_f32 v164, v164, v21, v20
    v_fma_f32 v165, v165, v21, v20
    v_mfma_f32_16x16x32_bf16 v[132:135], v[76:79], a[144:147], v[132:135]
    v_fma_f32 v166, v166, v21, v20
    v_fma_f32 v167, v167, v21, v20
    v_mfma_f32_16x16x32_bf16 v[140:143], v[76:79], a[148:151], v[140:143]
    buffer_load_dwordx4 v2, s[28:31], s73 offen offset:3072 sc1 lds
    v_mfma_f32_16x16x32_bf16 v[148:151], v[76:79], a[152:155], v[148:151]
    v_mul_f32 v160, v160, v184
    v_mul_f32 v161, v161, v185
    v_mfma_f32_16x16x32_bf16 v[156:159], v[76:79], a[156:159], v[156:159]
    v_mul_f32 v162, v162, v186
    v_mul_f32 v163, v163, v187
    s_waitcnt lgkmcnt(0)
    v_mfma_f32_16x16x32_bf16 v[128:131], v[80:83], a[160:163], v[128:131]
    v_mul_f32 v164, v164, v188
    v_mul_f32 v165, v165, v189
    v_mfma_f32_16x16x32_bf16 v[136:139], v[80:83], a[164:167], v[136:139]
    s_add_u32 m0, s55, 16384
    s_add_u32 s73, s47, 262144
    buffer_load_dwordx4 v2, s[28:31], s73 offen sc1 lds
    v_mfma_f32_16x16x32_bf16 v[144:147], v[80:83], a[168:171], v[144:147]
    v_mul_f32 v166, v166, v190
    v_mul_f32 v167, v167, v191
    v_mfma_f32_16x16x32_bf16 v[152:155], v[80:83], a[172:175], v[152:155]
    s_waitcnt vmcnt(14)
    ds_read_b64_tr_b16 v[64:65], v25 offset:0
    v_mfma_f32_16x16x32_bf16 v[132:135], v[84:87], a[160:163], v[132:135]
    ds_read_b64_tr_b16 v[66:67], v25 offset:1024
    v_mfma_f32_16x16x32_bf16 v[140:143], v[84:87], a[164:167], v[140:143]
    ds_read_b64_tr_b16 v[68:69], v26 offset:0
    buffer_load_dwordx4 v2, s[28:31], s73 offen offset:1024 sc1 lds
    v_mfma_f32_16x16x32_bf16 v[148:151], v[84:87], a[168:171], v[148:151]
    ds_read_b64_tr_b16 v[70:71], v26 offset:1024
    v_mfma_f32_16x16x32_bf16 v[156:159], v[84:87], a[172:175], v[156:159]
    ds_read_b64_tr_b16 v[72:73], v27 offset:0
    v_mfma_f32_16x16x32_bf16 v[128:131], v[88:91], a[176:179], v[128:131]
    ds_read_b64_tr_b16 v[74:75], v27 offset:1024
    v_mfma_f32_16x16x32_bf16 v[136:139], v[88:91], a[180:183], v[136:139]
    ds_read_b64_tr_b16 v[76:77], v28 offset:0
    buffer_load_dwordx4 v2, s[28:31], s73 offen offset:2048 sc1 lds
    v_mfma_f32_16x16x32_bf16 v[144:147], v[88:91], a[184:187], v[144:147]
    ds_read_b64_tr_b16 v[78:79], v28 offset:1024
    v_mfma_f32_16x16x32_bf16 v[152:155], v[88:91], a[188:191], v[152:155]
    v_exp_f32 v160, v160
    v_mfma_f32_16x16x32_bf16 v[132:135], v[92:95], a[176:179], v[132:135]
    v_exp_f32 v161, v161
    v_mfma_f32_16x16x32_bf16 v[140:143], v[92:95], a[180:183], v[140:143]
    buffer_load_dwordx4 v2, s[28:31], s73 offen offset:3072 sc1 lds
    v_mfma_f32_16x16x32_bf16 v[148:151], v[92:95], a[184:187], v[148:151]
    v_exp_f32 v162, v162
    v_mfma_f32_16x16x32_bf16 v[156:159], v[92:95], a[188:191], v[156:159]
    v_exp_f32 v163, v163
    s_waitcnt lgkmcnt(0)
    v_mfma_f32_16x16x32_bf16 v[128:131], v[64:67], a[192:195], v[128:131]
    v_exp_f32 v164, v164
    v_mfma_f32_16x16x32_bf16 v[136:139], v[64:67], a[196:199], v[136:139]
    s_add_u32 m0, s55, 0
    s_add_u32 s73, s47, 266240
    buffer_load_dwordx4 v2, s[28:31], s73 offen sc1 lds
    s_lshl_b32 s71, s48, 2
    s_add_u32 s71, s71, s50
    s_lshl_b32 s71, s71, 7
    s_add_u32 s71, s71, 16384
    s_lshl_b32 s70, s49, 2
    s_add_u32 s71, s71, s70
    s_waitcnt vmcnt(15)
    s_mov_b64 exec, 1
    buffer_store_dword v14, v13, s[28:31], s71 offen sc1
    s_mov_b64 exec, -1
    v_mfma_f32_16x16x32_bf16 v[144:147], v[64:67], a[200:203], v[144:147]
    v_exp_f32 v165, v165
    v_mfma_f32_16x16x32_bf16 v[152:155], v[64:67], a[204:207], v[152:155]
    s_waitcnt vmcnt(14)
    ds_read_b64_tr_b16 v[80:81], v25 offset:4096
    v_mfma_f32_16x16x32_bf16 v[132:135], v[68:71], a[192:195], v[132:135]
    ds_read_b64_tr_b16 v[82:83], v25 offset:5120
    v_mfma_f32_16x16x32_bf16 v[140:143], v[68:71], a[196:199], v[140:143]
    ds_read_b64_tr_b16 v[84:85], v26 offset:4096
    buffer_load_dwordx4 v2, s[28:31], s73 offen offset:1024 sc1 lds
    v_mfma_f32_16x16x32_bf16 v[148:151], v[68:71], a[200:203], v[148:151]
    ds_read_b64_tr_b16 v[86:87], v26 offset:5120
    v_mfma_f32_16x16x32_bf16 v[156:159], v[68:71], a[204:207], v[156:159]
    ds_read_b64_tr_b16 v[88:89], v27 offset:4096
    v_mfma_f32_16x16x32_bf16 v[128:131], v[72:75], a[208:211], v[128:131]
    ds_read_b64_tr_b16 v[90:91], v27 offset:5120
    v_mfma_f32_16x16x32_bf16 v[136:139], v[72:75], a[212:215], v[136:139]
    ds_read_b64_tr_b16 v[92:93], v28 offset:4096
    buffer_load_dwordx4 v2, s[28:31], s73 offen offset:2048 sc1 lds
    v_mfma_f32_16x16x32_bf16 v[144:147], v[72:75], a[216:219], v[144:147]
    ds_read_b64_tr_b16 v[94:95], v28 offset:5120
    v_mfma_f32_16x16x32_bf16 v[152:155], v[72:75], a[220:223], v[152:155]
    v_exp_f32 v166, v166
    v_mfma_f32_16x16x32_bf16 v[132:135], v[76:79], a[208:211], v[132:135]
    v_exp_f32 v167, v167
    v_mfma_f32_16x16x32_bf16 v[140:143], v[76:79], a[212:215], v[140:143]
    buffer_load_dwordx4 v2, s[28:31], s73 offen offset:3072 sc1 lds
    v_mfma_f32_16x16x32_bf16 v[148:151], v[76:79], a[216:219], v[148:151]
    v_add_f32 v160, 1.0, v160
    v_add_f32 v161, 1.0, v161
    v_mfma_f32_16x16x32_bf16 v[156:159], v[76:79], a[220:223], v[156:159]
    v_add_f32 v162, 1.0, v162
    v_add_f32 v163, 1.0, v163
    s_waitcnt lgkmcnt(0)
    v_mfma_f32_16x16x32_bf16 v[128:131], v[80:83], a[224:227], v[128:131]
    v_add_f32 v164, 1.0, v164
    v_add_f32 v165, 1.0, v165
    v_mfma_f32_16x16x32_bf16 v[136:139], v[80:83], a[228:231], v[136:139]
    s_add_u32 m0, s55, 4096
    s_add_u32 s73, s57, 262144
    buffer_load_dwordx4 v2, s[28:31], s73 offen sc1 lds
    v_mfma_f32_16x16x32_bf16 v[144:147], v[80:83], a[232:235], v[144:147]
    v_add_f32 v166, 1.0, v166
    v_add_f32 v167, 1.0, v167
    v_mfma_f32_16x16x32_bf16 v[152:155], v[80:83], a[236:239], v[152:155]
    s_waitcnt vmcnt(14)
    ds_read_b64_tr_b16 v[64:65], v25 offset:8192
    v_mfma_f32_16x16x32_bf16 v[132:135], v[84:87], a[224:227], v[132:135]
    ds_read_b64_tr_b16 v[66:67], v25 offset:9216
    v_mfma_f32_16x16x32_bf16 v[140:143], v[84:87], a[228:231], v[140:143]
    ds_read_b64_tr_b16 v[68:69], v26 offset:8192
    buffer_load_dwordx4 v2, s[28:31], s73 offen offset:1024 sc1 lds
    v_mfma_f32_16x16x32_bf16 v[148:151], v[84:87], a[232:235], v[148:151]
    ds_read_b64_tr_b16 v[70:71], v26 offset:9216
    v_mfma_f32_16x16x32_bf16 v[156:159], v[84:87], a[236:239], v[156:159]
    ds_read_b64_tr_b16 v[72:73], v27 offset:8192
    v_mfma_f32_16x16x32_bf16 v[128:131], v[88:91], a[240:243], v[128:131]
    ds_read_b64_tr_b16 v[74:75], v27 offset:9216
    v_mfma_f32_16x16x32_bf16 v[136:139], v[88:91], a[244:247], v[136:139]
    ds_read_b64_tr_b16 v[76:77], v28 offset:8192
    buffer_load_dwordx4 v2, s[28:31], s73 offen offset:2048 sc1 lds
    v_mfma_f32_16x16x32_bf16 v[144:147], v[88:91], a[248:251], v[144:147]
    ds_read_b64_tr_b16 v[78:79], v28 offset:9216
    v_mfma_f32_16x16x32_bf16 v[152:155], v[88:91], a[252:255], v[152:155]
    v_rcp_f32 v160, v160
    v_mfma_f32_16x16x32_bf16 v[132:135], v[92:95], a[240:243], v[132:135]
    v_rcp_f32 v161, v161
    v_mfma_f32_16x16x32_bf16 v[140:143], v[92:95], a[244:247], v[140:143]
    buffer_load_dwordx4 v2, s[28:31], s73 offen offset:3072 sc1 lds
    v_mfma_f32_16x16x32_bf16 v[148:151], v[92:95], a[248:251], v[148:151]
    v_rcp_f32 v162, v162
    v_mfma_f32_16x16x32_bf16 v[156:159], v[92:95], a[252:255], v[156:159]
    ds_read_b64_tr_b16 v[192:193], v49 offset:0
    ds_read_b64_tr_b16 v[194:195], v49 offset:1280
    ds_read_b64_tr_b16 v[196:197], v49 offset:32
    ds_read_b64_tr_b16 v[198:199], v49 offset:1312
    ds_read_b64_tr_b16 v[200:201], v39 offset:0
    ds_read_b64_tr_b16 v[202:203], v39 offset:1280
    ds_read_b64_tr_b16 v[204:205], v49 offset:10256
    ds_read_b64_tr_b16 v[206:207], v49 offset:11536
    ds_read_b64_tr_b16 v[208:209], v42 offset:0
    ds_read_b64_tr_b16 v[210:211], v42 offset:1280
    s_waitcnt lgkmcnt(0)
    v_mfma_f32_16x16x32_bf16 v[16:19], v[192:195], v[240:243], 0
    ds_read_b64_tr_b16 v[212:213], v49 offset:128
    ds_read_b64_tr_b16 v[214:215], v49 offset:1408
    ds_read_b64_tr_b16 v[216:217], v49 offset:160
    v_mfma_f32_16x16x32_bf16 v[52:55], v[196:199], v[240:243], 0
    ds_read_b64_tr_b16 v[218:219], v49 offset:1440
    ds_read_b64_tr_b16 v[220:221], v43 offset:0
    ds_read_b64_tr_b16 v[222:223], v43 offset:1280
    v_mfma_f32_16x16x32_bf16 v[56:59], v[200:203], v[240:243], 0
    ds_read_b64_tr_b16 v[224:225], v49 offset:10384
    ds_read_b64_tr_b16 v[226:227], v49 offset:11664
    v_mfma_f32_16x16x32_bf16 v[60:63], v[204:207], v[240:243], 0
    ds_read_b64_tr_b16 v[228:229], v44 offset:0
    ds_read_b64_tr_b16 v[230:231], v44 offset:1280
    v_mfma_f32_16x16x32_bf16 v[236:239], v[208:211], v[240:243], 0
    v_rcp_f32 v163, v163
    s_waitcnt lgkmcnt(0)
    v_mfma_f32_16x16x32_bf16 v[16:19], v[212:215], v[244:247], v[16:19]
    ds_read_b64_tr_b16 v[192:193], v49 offset:64
    ds_read_b64_tr_b16 v[194:195], v49 offset:1344
    ds_read_b64_tr_b16 v[196:197], v49 offset:96
    v_mfma_f32_16x16x32_bf16 v[52:55], v[216:219], v[244:247], v[52:55]
    ds_read_b64_tr_b16 v[198:199], v49 offset:1376
    ds_read_b64_tr_b16 v[200:201], v45 offset:0
    ds_read_b64_tr_b16 v[202:203], v45 offset:1280
    v_mfma_f32_16x16x32_bf16 v[56:59], v[220:223], v[244:247], v[56:59]
    ds_read_b64_tr_b16 v[204:205], v49 offset:10320
    ds_read_b64_tr_b16 v[206:207], v49 offset:11600
    v_mfma_f32_16x16x32_bf16 v[60:63], v[224:227], v[244:247], v[60:63]
    ds_read_b64_tr_b16 v[208:209], v46 offset:0
    ds_read_b64_tr_b16 v[210:211], v46 offset:1280
    v_mfma_f32_16x16x32_bf16 v[236:239], v[228:231], v[244:247], v[236:239]
    v_rcp_f32 v164, v164
    s_waitcnt lgkmcnt(0)
    v_mfma_f32_16x16x32_bf16 v[16:19], v[192:195], v[248:251], v[16:19]
    ds_read_b64_tr_b16 v[212:213], v49 offset:192
    ds_read_b64_tr_b16 v[214:215], v49 offset:1472
    ds_read_b64_tr_b16 v[216:217], v49 offset:224
    v_mfma_f32_16x16x32_bf16 v[52:55], v[196:199], v[248:251], v[52:55]
    ds_read_b64_tr_b16 v[218:219], v49 offset:1504
    ds_read_b64_tr_b16 v[220:221], v47 offset:0
    ds_read_b64_tr_b16 v[222:223], v47 offset:1280
    v_mfma_f32_16x16x32_bf16 v[56:59], v[200:203], v[248:251], v[56:59]
    ds_read_b64_tr_b16 v[224:225], v49 offset:10448
    ds_read_b64_tr_b16 v[226:227], v49 offset:11728
    v_mfma_f32_16x16x32_bf16 v[60:63], v[204:207], v[248:251], v[60:63]
    ds_read_b64_tr_b16 v[228:229], v48 offset:0
    ds_read_b64_tr_b16 v[230:231], v48 offset:1280
    v_mfma_f32_16x16x32_bf16 v[236:239], v[208:211], v[248:251], v[236:239]
    v_rcp_f32 v165, v165
    s_waitcnt lgkmcnt(0)
    v_mfma_f32_16x16x32_bf16 v[16:19], v[212:215], v[252:255], v[16:19]
    v_rcp_f32 v166, v166
    v_mfma_f32_16x16x32_bf16 v[52:55], v[216:219], v[252:255], v[52:55]
    v_rcp_f32 v167, v167
    v_mfma_f32_16x16x32_bf16 v[56:59], v[220:223], v[252:255], v[56:59]
    v_mul_f32 v184, v184, v160
    v_mul_f32 v185, v185, v161
    v_mfma_f32_16x16x32_bf16 v[60:63], v[224:227], v[252:255], v[60:63]
    v_mul_f32 v186, v186, v162
    v_mul_f32 v187, v187, v163
    v_mfma_f32_16x16x32_bf16 v[236:239], v[228:231], v[252:255], v[236:239]
    v_mul_f32 v188, v188, v164
    v_mul_f32 v189, v189, v165
    v_mfma_f32_16x16x32_bf16 v[96:99], v[64:67], a[0:3], 0
    v_mul_f32 v190, v190, v166
    v_mul_f32 v191, v191, v167
    v_mfma_f32_16x16x32_bf16 v[104:107], v[64:67], a[4:7], 0
    v_mul_f32 v184, v184, v41
    v_mul_f32 v185, v185, v41
    v_mfma_f32_16x16x32_bf16 v[112:115], v[64:67], a[8:11], 0
    v_mul_f32 v186, v186, v41
    v_mul_f32 v187, v187, v41
    v_mfma_f32_16x16x32_bf16 v[120:123], v[64:67], a[12:15], 0
    s_waitcnt vmcnt(13)
    ds_read_b64_tr_b16 v[80:81], v25 offset:12288
    s_barrier
    v_mfma_f32_16x16x32_bf16 v[100:103], v[68:71], a[0:3], 0
    ds_read_b64_tr_b16 v[82:83], v25 offset:13312
    v_mul_f32 v188, v188, v41
    v_mfma_f32_16x16x32_bf16 v[108:111], v[68:71], a[4:7], 0
    ds_read_b64_tr_b16 v[84:85], v26 offset:12288
    ds_write_b128 v30, v[136:139] offset:0
    ds_write_b128 v30, v[140:143] offset:1024
    v_mfma_f32_16x16x32_bf16 v[116:119], v[68:71], a[8:11], 0
    ds_read_b64_tr_b16 v[86:87], v26 offset:13312
    v_mul_f32 v189, v189, v41
    v_mfma_f32_16x16x32_bf16 v[124:127], v[68:71], a[12:15], 0
    ds_read_b64_tr_b16 v[88:89], v27 offset:12288
    ds_write_b128 v31, v[144:147] offset:0
    ds_write_b128 v31, v[148:151] offset:1024
    v_mfma_f32_16x16x32_bf16 v[96:99], v[72:75], a[16:19], v[96:99]
    ds_read_b64_tr_b16 v[90:91], v27 offset:13312
    v_mul_f32 v190, v190, v41
    v_mfma_f32_16x16x32_bf16 v[104:107], v[72:75], a[20:23], v[104:107]
    ds_read_b64_tr_b16 v[92:93], v28 offset:12288
    ds_write_b128 v32, v[152:155] offset:0
    ds_write_b128 v32, v[156:159] offset:1024
    v_mfma_f32_16x16x32_bf16 v[112:115], v[72:75], a[24:27], v[112:115]
    ds_read_b64_tr_b16 v[94:95], v28 offset:13312
    v_mul_f32 v191, v191, v41
    v_mfma_f32_16x16x32_bf16 v[120:123], v[72:75], a[28:31], v[120:123]
    v_mfma_f32_16x16x32_bf16 v[100:103], v[76:79], a[16:19], v[100:103]
    v_mfma_f32_16x16x32_bf16 v[108:111], v[76:79], a[20:23], v[108:111]
    v_mfma_f32_16x16x32_bf16 v[116:119], v[76:79], a[24:27], v[116:119]
    v_mfma_f32_16x16x32_bf16 v[124:127], v[76:79], a[28:31], v[124:127]
    s_add_u32 m0, s55, 8192
    s_add_u32 s73, s57, 266240
    buffer_load_dwordx4 v2, s[28:31], s73 offen sc1 lds
    buffer_load_dwordx4 v2, s[28:31], s73 offen offset:1024 sc1 lds
    buffer_load_dwordx4 v2, s[28:31], s73 offen offset:2048 sc1 lds
    buffer_load_dwordx4 v2, s[28:31], s73 offen offset:3072 sc1 lds
    s_waitcnt lgkmcnt(0)
    v_mfma_f32_16x16x32_bf16 v[96:99], v[80:83], a[32:35], v[96:99]
    v_mfma_f32_16x16x32_bf16 v[104:107], v[80:83], a[36:39], v[104:107]
    s_add_u32 m0, s55, 12288
    s_add_u32 s73, s66, 262144
    buffer_load_dwordx4 v2, s[28:31], s73 offen sc1 lds
    v_mfma_f32_16x16x32_bf16 v[112:115], v[80:83], a[40:43], v[112:115]
    v_mfma_f32_16x16x32_bf16 v[120:123], v[80:83], a[44:47], v[120:123]
    s_waitcnt vmcnt(14)
    ds_read_b64_tr_b16 v[64:65], v25 offset:16384
    s_barrier
    ds_read_b128 v[136:139], v29 offset:0
    ds_read_b128 v[140:143], v29 offset:1024
    ds_read_b128 v[144:147], v29 offset:2048
    v_mfma_f32_16x16x32_bf16 v[100:103], v[84:87], a[32:35], v[100:103]
    ds_read_b64_tr_b16 v[66:67], v25 offset:17408
    v_mfma_f32_16x16x32_bf16 v[108:111], v[84:87], a[36:39], v[108:111]
    ds_read_b64_tr_b16 v[68:69], v26 offset:16384
    buffer_load_dwordx4 v2, s[28:31], s73 offen offset:1024 sc1 lds
    ds_read_b128 v[148:151], v29 offset:3072
    ds_read_b128 v[152:155], v29 offset:4096
    ds_read_b128 v[156:159], v29 offset:5120
    v_mfma_f32_16x16x32_bf16 v[116:119], v[84:87], a[40:43], v[116:119]
    ds_read_b64_tr_b16 v[70:71], v26 offset:17408
    v_mfma_f32_16x16x32_bf16 v[124:127], v[84:87], a[44:47], v[124:127]
    ds_read_b64_tr_b16 v[72:73], v27 offset:16384
    v_pk_add_f32 v[128:129], v[128:129], v[22:23] op_sel_hi:[1,0]
    v_pk_add_f32 v[130:131], v[130:131], v[22:23] op_sel_hi:[1,0]
    v_pk_add_f32 v[132:133], v[132:133], v[22:23] op_sel_hi:[1,0]
    s_nop 0
    v_mfma_f32_16x16x32_bf16 v[96:99], v[88:91], a[48:51], v[96:99]
    ds_read_b64_tr_b16 v[74:75], v27 offset:17408
    v_mfma_f32_16x16x32_bf16 v[104:107], v[88:91], a[52:55], v[104:107]
    ds_read_b64_tr_b16 v[76:77], v28 offset:16384
    buffer_load_dwordx4 v2, s[28:31], s73 offen offset:2048 sc1 lds
    v_pk_add_f32 v[134:135], v[134:135], v[22:23] op_sel_hi:[1,0]
    s_waitcnt lgkmcnt(11)
    v_pk_add_f32 v[128:129], v[128:129], v[136:137]
    v_pk_add_f32 v[130:131], v[130:131], v[138:139]
    s_nop 0
    v_mfma_f32_16x16x32_bf16 v[112:115], v[88:91], a[56:59], v[112:115]
    ds_read_b64_tr_b16 v[78:79], v28 offset:17408
    v_mfma_f32_16x16x32_bf16 v[120:123], v[88:91], a[60:63], v[120:123]
    s_waitcnt lgkmcnt(11)
    v_pk_add_f32 v[132:133], v[132:133], v[140:141]
    v_pk_add_f32 v[134:135], v[134:135], v[142:143]
    s_waitcnt lgkmcnt(6)
    v_pk_add_f32 v[144:145], v[144:145], v[152:153]
    s_nop 0
    v_mfma_f32_16x16x32_bf16 v[100:103], v[92:95], a[48:51], v[100:103]
    v_mfma_f32_16x16x32_bf16 v[108:111], v[92:95], a[52:55], v[108:111]
    buffer_load_dwordx4 v2, s[28:31], s73 offen offset:3072 sc1 lds
    v_pk_add_f32 v[146:147], v[146:147], v[154:155]
    s_waitcnt lgkmcnt(5)
    v_pk_add_f32 v[148:149], v[148:149], v[156:157]
    v_pk_add_f32 v[150:151], v[150:151], v[158:159]
    s_nop 0
    v_mfma_f32_16x16x32_bf16 v[116:119], v[92:95], a[56:59], v[116:119]
    v_mfma_f32_16x16x32_bf16 v[124:127], v[92:95], a[60:63], v[124:127]
    s_add_u32 m0, s83, 81920
    s_add_u32 s74, s78, 0
    buffer_load_dwordx4 v2, s[28:31], s74 offen sc1 lds
    v_pk_add_f32 v[128:129], v[128:129], v[144:145]
    buffer_load_dwordx4 v2, s[28:31], s74 offen offset:1024 sc1 lds
    v_pk_add_f32 v[130:131], v[130:131], v[146:147]
    buffer_load_dwordx4 v2, s[28:31], s74 offen offset:2048 sc1 lds
    v_pk_add_f32 v[132:133], v[132:133], v[148:149]
    buffer_load_dwordx4 v2, s[28:31], s74 offen offset:3072 sc1 lds
    s_lshl_b32 s75, s48, 2
    s_add_u32 s75, s75, s50
    s_lshl_b32 s75, s75, 7
    s_add_u32 s75, s75, 16384
    buffer_load_dword v5, v36, s[28:31], s75 offen sc1
    v_mfma_f32_16x16x32_bf16 v[96:99], v[64:67], a[64:67], v[96:99]
    v_mfma_f32_16x16x32_bf16 v[104:107], v[64:67], a[68:71], v[104:107]
    s_add_u32 m0, s83, 86016
    s_add_u32 s74, s78, 4096
    buffer_load_dwordx4 v2, s[28:31], s74 offen sc1 lds
    s_add_u32 m0, s55, 16384
    s_add_u32 s73, s66, 266240
    s_waitcnt lgkmcnt(0)
    buffer_load_dwordx4 v2, s[28:31], s73 offen sc1 lds
    v_pk_add_f32 v[134:135], v[134:135], v[150:151]
    v_pk_mul_f32 v[128:129], v[128:129], v[176:177]
    v_pk_mul_f32 v[130:131], v[130:131], v[178:179]
    s_nop 0
    v_mfma_f32_16x16x32_bf16 v[112:115], v[64:67], a[72:75], v[112:115]
    v_mfma_f32_16x16x32_bf16 v[120:123], v[64:67], a[76:79], v[120:123]
    s_waitcnt vmcnt(19)
    ds_read_b64_tr_b16 v[80:81], v25 offset:0
    v_pk_mul_f32 v[132:133], v[132:133], v[180:181]
    v_pk_mul_f32 v[134:135], v[134:135], v[182:183]
    v_cvt_pk_bf16_f32 v136, v128, v129
    s_add_u32 m0, s83, 86016
    v_mfma_f32_16x16x32_bf16 v[100:103], v[68:71], a[64:67], v[100:103]
    buffer_load_dwordx4 v2, s[28:31], s74 offen offset:1024 sc1 lds
    ds_read_b64_tr_b16 v[82:83], v25 offset:1024
    v_mfma_f32_16x16x32_bf16 v[108:111], v[68:71], a[68:71], v[108:111]
    s_add_u32 m0, s55, 16384
    ds_read_b64_tr_b16 v[84:85], v26 offset:0
    buffer_load_dwordx4 v2, s[28:31], s73 offen offset:1024 sc1 lds
    v_cvt_pk_bf16_f32 v137, v130, v131
    v_cvt_pk_bf16_f32 v138, v132, v133
    v_cvt_pk_bf16_f32 v139, v134, v135
    v_mfma_f32_16x16x32_bf16 v[116:119], v[68:71], a[72:75], v[116:119]
    ds_read_b64_tr_b16 v[86:87], v26 offset:1024
    v_mfma_f32_16x16x32_bf16 v[124:127], v[68:71], a[76:79], v[124:127]
    s_add_u32 m0, s83, 86016
    ds_read_b64_tr_b16 v[88:89], v27 offset:0
    buffer_load_dwordx4 v2, s[28:31], s74 offen offset:2048 sc1 lds
    s_add_u32 s68, s85, 8192
    buffer_store_dwordx4 v[136:139], v2, s[28:31], s68 offen sc1
    v_mfma_f32_16x16x32_bf16 v[96:99], v[72:75], a[80:83], v[96:99]
    ds_read_b64_tr_b16 v[90:91], v27 offset:1024
    v_mfma_f32_16x16x32_bf16 v[104:107], v[72:75], a[84:87], v[104:107]
    s_add_u32 m0, s55, 16384
    ds_read_b64_tr_b16 v[92:93], v28 offset:0
    buffer_load_dwordx4 v2, s[28:31], s73 offen offset:2048 sc1 lds
    v_mfma_f32_16x16x32_bf16 v[112:115], v[72:75], a[88:91], v[112:115]
    ds_read_b64_tr_b16 v[94:95], v28 offset:1024
    v_mfma_f32_16x16x32_bf16 v[120:123], v[72:75], a[92:95], v[120:123]
    s_add_u32 m0, s83, 86016
    v_mfma_f32_16x16x32_bf16 v[100:103], v[76:79], a[80:83], v[100:103]
    buffer_load_dwordx4 v2, s[28:31], s74 offen offset:3072 sc1 lds
    s_add_u32 m0, s55, 16384
    v_mfma_f32_16x16x32_bf16 v[108:111], v[76:79], a[84:87], v[108:111]
    buffer_load_dwordx4 v2, s[28:31], s73 offen offset:3072 sc1 lds
    v_mfma_f32_16x16x32_bf16 v[116:119], v[76:79], a[88:91], v[116:119]
    v_mfma_f32_16x16x32_bf16 v[124:127], v[76:79], a[92:95], v[124:127]
    s_waitcnt vmcnt(9)
    v_cmp_ne_u32 vcc, s53, v5
    s_nop 0
    s_cbranch_vccnz L_slow3
L_back3:
    s_waitcnt lgkmcnt(0)
    v_mfma_f32_16x16x32_bf16 v[96:99], v[80:83], a[96:99], v[96:99]
    v_mfma_f32_16x16x32_bf16 v[104:107], v[80:83], a[100:103], v[104:107]
    s_add_u32 m0, s84, 114688
    s_add_u32 s74, s79, 32768
    buffer_load_dwordx4 v2, s[28:31], s74 offen sc1 lds
    v_mfma_f32_16x16x32_bf16 v[112:115], v[80:83], a[104:107], v[112:115]
    v_mfma_f32_16x16x32_bf16 v[120:123], v[80:83], a[108:111], v[120:123]
    ds_read_b64_tr_b16 v[64:65], v25 offset:4096
    v_mfma_f32_16x16x32_bf16 v[100:103], v[84:87], a[96:99], v[100:103]
    ds_read_b64_tr_b16 v[66:67], v25 offset:5120
    v_mfma_f32_16x16x32_bf16 v[108:111], v[84:87], a[100:103], v[108:111]
    ds_read_b64_tr_b16 v[68:69], v26 offset:4096
    v_mfma_f32_16x16x32_bf16 v[116:119], v[84:87], a[104:107], v[116:119]
    buffer_load_dwordx4 v2, s[28:31], s74 offen offset:1024 sc1 lds
    ds_read_b64_tr_b16 v[70:71], v26 offset:5120
    v_mfma_f32_16x16x32_bf16 v[124:127], v[84:87], a[108:111], v[124:127]
    ds_read_b64_tr_b16 v[72:73], v27 offset:4096
    v_mfma_f32_16x16x32_bf16 v[96:99], v[88:91], a[112:115], v[96:99]
    ds_read_b64_tr_b16 v[74:75], v27 offset:5120
    v_mfma_f32_16x16x32_bf16 v[104:107], v[88:91], a[116:119], v[104:107]
    ds_read_b64_tr_b16 v[76:77], v28 offset:4096
    v_mfma_f32_16x16x32_bf16 v[112:115], v[88:91], a[120:123], v[112:115]
    ds_read_b64_tr_b16 v[78:79], v28 offset:5120
    v_mfma_f32_16x16x32_bf16 v[120:123], v[88:91], a[124:127], v[120:123]
    s_add_u32 m0, s55, 0
    s_add_u32 s74, s80, 40960
    buffer_load_dwordx4 v2, s[28:31], s74 offen sc1 lds
    v_mfma_f32_16x16x32_bf16 v[100:103], v[92:95], a[112:115], v[100:103]
    v_mfma_f32_16x16x32_bf16 v[108:111], v[92:95], a[116:119], v[108:111]
    v_mfma_f32_16x16x32_bf16 v[116:119], v[92:95], a[120:123], v[116:119]
    v_mfma_f32_16x16x32_bf16 v[124:127], v[92:95], a[124:127], v[124:127]
    s_waitcnt lgkmcnt(0)
    v_mfma_f32_16x16x32_bf16 v[96:99], v[64:67], a[128:131], v[96:99]
    buffer_load_dwordx4 v2, s[28:31], s74 offen offset:1024 sc1 lds
    v_mfma_f32_16x16x32_bf16 v[104:107], v[64:67], a[132:135], v[104:107]
    v_mfma_f32_16x16x32_bf16 v[112:115], v[64:67], a[136:139], v[112:115]
    v_mfma_f32_16x16x32_bf16 v[120:123], v[64:67], a[140:143], v[120:123]
    ds_read_b64_tr_b16 v[80:81], v25 offset:8192
    v_mfma_f32_16x16x32_bf16 v[100:103], v[68:71], a[128:131], v[100:103]
    ds_read_b64_tr_b16 v[82:83], v25 offset:9216
    v_mfma_f32_16x16x32_bf16 v[108:111], v[68:71], a[132:135], v[108:111]
    buffer_load_dwordx4 v2, s[28:31], s74 offen offset:2048 sc1 lds
    ds_read_b64_tr_b16 v[84:85], v26 offset:8192
    v_mfma_f32_16x16x32_bf16 v[116:119], v[68:71], a[136:139], v[116:119]
    ds_read_b64_tr_b16 v[86:87], v26 offset:9216
    v_mfma_f32_16x16x32_bf16 v[124:127], v[68:71], a[140:143], v[124:127]
    ds_read_b64_tr_b16 v[88:89], v27 offset:8192
    v_mfma_f32_16x16x32_bf16 v[96:99], v[72:75], a[144:147], v[96:99]
    ds_read_b64_tr_b16 v[90:91], v27 offset:9216
    v_mfma_f32_16x16x32_bf16 v[104:107], v[72:75], a[148:151], v[104:107]
    ds_read_b64_tr_b16 v[92:93], v28 offset:8192
    v_mfma_f32_16x16x32_bf16 v[112:115], v[72:75], a[152:155], v[112:115]
    buffer_load_dwordx4 v2, s[28:31], s74 offen offset:3072 sc1 lds
    ds_read_b64_tr_b16 v[94:95], v28 offset:9216
    v_mfma_f32_16x16x32_bf16 v[120:123], v[72:75], a[156:159], v[120:123]
    v_mfma_f32_16x16x32_bf16 v[100:103], v[76:79], a[144:147], v[100:103]
    v_mfma_f32_16x16x32_bf16 v[108:111], v[76:79], a[148:151], v[108:111]
    v_mfma_f32_16x16x32_bf16 v[116:119], v[76:79], a[152:155], v[116:119]
    v_mfma_f32_16x16x32_bf16 v[124:127], v[76:79], a[156:159], v[124:127]
    s_add_u32 m0, s55, 4096
    s_add_u32 s74, s80, 45056
    buffer_load_dwordx4 v2, s[28:31], s74 offen sc1 lds
    s_waitcnt lgkmcnt(0)
    v_mfma_f32_16x16x32_bf16 v[96:99], v[80:83], a[160:163], v[96:99]
    v_mfma_f32_16x16x32_bf16 v[104:107], v[80:83], a[164:167], v[104:107]
    v_mfma_f32_16x16x32_bf16 v[112:115], v[80:83], a[168:171], v[112:115]
    v_mfma_f32_16x16x32_bf16 v[120:123], v[80:83], a[172:175], v[120:123]
    ds_read_b64_tr_b16 v[64:65], v25 offset:12288
    v_mfma_f32_16x16x32_bf16 v[100:103], v[84:87], a[160:163], v[100:103]
    ds_read_b64_tr_b16 v[66:67], v25 offset:13312
    buffer_load_dwordx4 v2, s[28:31], s74 offen offset:1024 sc1 lds
    v_mfma_f32_16x16x32_bf16 v[108:111], v[84:87], a[164:167], v[108:111]
    ds_read_b64_tr_b16 v[68:69], v26 offset:12288
    v_mfma_f32_16x16x32_bf16 v[116:119], v[84:87], a[168:171], v[116:119]
    ds_read_b64_tr_b16 v[70:71], v26 offset:13312
    v_mfma_f32_16x16x32_bf16 v[124:127], v[84:87], a[172:175], v[124:127]
    ds_read_b64_tr_b16 v[72:73], v27 offset:12288
    v_mfma_f32_16x16x32_bf16 v[96:99], v[88:91], a[176:179], v[96:99]
    ds_read_b64_tr_b16 v[74:75], v27 offset:13312
    v_mfma_f32_16x16x32_bf16 v[104:107], v[88:91], a[180:183], v[104:107]
    buffer_load_dwordx4 v2, s[28:31], s74 offen offset:2048 sc1 lds
    ds_read_b64_tr_b16 v[76:77], v28 offset:12288
    v_mfma_f32_16x16x32_bf16 v[112:115], v[88:91], a[184:187], v[112:115]
    ds_read_b64_tr_b16 v[78:79], v28 offset:13312
    v_mfma_f32_16x16x32_bf16 v[120:123], v[88:91], a[188:191], v[120:123]
    v_mfma_f32_16x16x32_bf16 v[100:103], v[92:95], a[176:179], v[100:103]
    v_mfma_f32_16x16x32_bf16 v[108:111], v[92:95], a[180:183], v[108:111]
    v_mfma_f32_16x16x32_bf16 v[116:119], v[92:95], a[184:187], v[116:119]
    buffer_load_dwordx4 v2, s[28:31], s74 offen offset:3072 sc1 lds
    v_mfma_f32_16x16x32_bf16 v[124:127], v[92:95], a[188:191], v[124:127]
    s_waitcnt lgkmcnt(0)
    v_mfma_f32_16x16x32_bf16 v[96:99], v[64:67], a[192:195], v[96:99]
    v_mfma_f32_16x16x32_bf16 v[104:107], v[64:67], a[196:199], v[104:107]
    s_lshl_b32 s71, s48, 2
    s_add_u32 s71, s71, s50
    s_lshl_b32 s71, s71, 7
    s_add_u32 s71, s71, 32768
    s_lshl_b32 s70, s49, 2
    s_add_u32 s71, s71, s70
    s_waitcnt vmcnt(13)
    s_mov_b64 exec, 1
    buffer_store_dword v14, v13, s[28:31], s71 offen sc1
    s_mov_b64 exec, -1
    s_add_u32 m0, s55, 8192
    s_add_u32 s74, s80, 49152
    buffer_load_dwordx4 v2, s[28:31], s74 offen sc1 lds
    v_mfma_f32_16x16x32_bf16 v[112:115], v[64:67], a[200:203], v[112:115]
    v_mfma_f32_16x16x32_bf16 v[120:123], v[64:67], a[204:207], v[120:123]
    s_waitcnt vmcnt(12)
    ds_read_b64_tr_b16 v[80:81], v25 offset:16384
    v_mfma_f32_16x16x32_bf16 v[100:103], v[68:71], a[192:195], v[100:103]
    ds_read_b64_tr_b16 v[82:83], v25 offset:17408
    v_mfma_f32_16x16x32_bf16 v[108:111], v[68:71], a[196:199], v[108:111]
    ds_read_b64_tr_b16 v[84:85], v26 offset:16384
    v_mfma_f32_16x16x32_bf16 v[116:119], v[68:71], a[200:203], v[116:119]
    buffer_load_dwordx4 v2, s[28:31], s74 offen offset:1024 sc1 lds
    ds_read_b64_tr_b16 v[86:87], v26 offset:17408
    v_mfma_f32_16x16x32_bf16 v[124:127], v[68:71], a[204:207], v[124:127]
    ds_read_b64_tr_b16 v[88:89], v27 offset:16384
    v_mfma_f32_16x16x32_bf16 v[96:99], v[72:75], a[208:211], v[96:99]
    ds_read_b64_tr_b16 v[90:91], v27 offset:17408
    v_mfma_f32_16x16x32_bf16 v[104:107], v[72:75], a[212:215], v[104:107]
    ds_read_b64_tr_b16 v[92:93], v28 offset:16384
    v_mfma_f32_16x16x32_bf16 v[112:115], v[72:75], a[216:219], v[112:115]
    ds_read_b64_tr_b16 v[94:95], v28 offset:17408
    v_mfma_f32_16x16x32_bf16 v[120:123], v[72:75], a[220:223], v[120:123]
    s_add_u32 s73, s67, 0
    buffer_load_dwordx4 a[0:3], v2, s[28:31], s73 offen offset:0 sc1
    v_mfma_f32_16x16x32_bf16 v[100:103], v[76:79], a[208:211], v[100:103]
    v_mfma_f32_16x16x32_bf16 v[108:111], v[76:79], a[212:215], v[108:111]
    v_mfma_f32_16x16x32_bf16 v[116:119], v[76:79], a[216:219], v[116:119]
    v_mfma_f32_16x16x32_bf16 v[124:127], v[76:79], a[220:223], v[124:127]
    s_barrier
    s_waitcnt lgkmcnt(0)
    v_mfma_f32_16x16x32_bf16 v[96:99], v[80:83], a[224:227], v[96:99]
    buffer_load_dwordx4 a[4:7], v2, s[28:31], s73 offen offset:1024 sc1
    v_mfma_f32_16x16x32_bf16 v[104:107], v[80:83], a[228:231], v[104:107]
    v_mfma_f32_16x16x32_bf16 v[112:115], v[80:83], a[232:235], v[112:115]
    v_mfma_f32_16x16x32_bf16 v[120:123], v[80:83], a[236:239], v[120:123]
    v_mfma_f32_16x16x32_bf16 v[100:103], v[84:87], a[224:227], v[100:103]
    v_mfma_f32_16x16x32_bf16 v[108:111], v[84:87], a[228:231], v[108:111]
    v_mfma_f32_16x16x32_bf16 v[116:119], v[84:87], a[232:235], v[116:119]
    buffer_load_dwordx4 a[8:11], v2, s[28:31], s73 offen offset:2048 sc1
    v_mfma_f32_16x16x32_bf16 v[124:127], v[84:87], a[236:239], v[124:127]
    v_mfma_f32_16x16x32_bf16 v[96:99], v[88:91], a[240:243], v[96:99]
    v_mfma_f32_16x16x32_bf16 v[104:107], v[88:91], a[244:247], v[104:107]
    v_mfma_f32_16x16x32_bf16 v[112:115], v[88:91], a[248:251], v[112:115]
    v_mfma_f32_16x16x32_bf16 v[120:123], v[88:91], a[252:255], v[120:123]
    buffer_load_dwordx4 a[12:15], v2, s[28:31], s73 offen offset:3072 sc1
    v_mfma_f32_16x16x32_bf16 v[100:103], v[92:95], a[240:243], v[100:103]
    v_mfma_f32_16x16x32_bf16 v[108:111], v[92:95], a[244:247], v[108:111]
    v_mfma_f32_16x16x32_bf16 v[116:119], v[92:95], a[248:251], v[116:119]
    v_mfma_f32_16x16x32_bf16 v[124:127], v[92:95], a[252:255], v[124:127]
    s_nop 0
    ds_write_b128 v30, v[104:107] offset:0
    s_add_u32 s74, s67, 4096
    buffer_load_dwordx4 a[16:19], v2, s[28:31], s74 offen offset:0 sc1
    s_nop 1
    ds_write_b128 v30, v[108:111] offset:1024
    ds_write_b128 v31, v[112:115] offset:0
    buffer_load_dwordx4 a[20:23], v2, s[28:31], s74 offen offset:1024 sc1
    ds_write_b128 v31, v[116:119] offset:1024
    ds_write_b128 v32, v[120:123] offset:0
    buffer_load_dwordx4 a[24:27], v2, s[28:31], s74 offen offset:2048 sc1
    ds_write_b128 v32, v[124:127] offset:1024
    s_waitcnt vmcnt(7) lgkmcnt(0)
    s_barrier
    ds_read_b128 v[104:107], v29 offset:0
    buffer_load_dwordx4 a[28:31], v2, s[28:31], s74 offen offset:3072 sc1
    ds_read_b128 v[108:111], v29 offset:1024
    ds_read_b128 v[112:115], v29 offset:2048
    ds_read_b128 v[116:119], v29 offset:3072
    ds_read_b128 v[120:123], v29 offset:4096
    ds_read_b128 v[124:127], v29 offset:5120
    v_pk_add_f32 v[96:97], v[96:97], v[22:23] op_sel_hi:[1,0]
    v_pk_add_f32 v[98:99], v[98:99], v[22:23] op_sel_hi:[1,0]
    v_pk_add_f32 v[100:101], v[100:101], v[22:23] op_sel_hi:[1,0]
    v_pk_add_f32 v[102:103], v[102:103], v[22:23] op_sel_hi:[1,0]
    s_waitcnt lgkmcnt(5)
    v_pk_add_f32 v[96:97], v[96:97], v[104:105]
    v_pk_add_f32 v[98:99], v[98:99], v[106:107]
    s_waitcnt lgkmcnt(4)
    v_pk_add_f32 v[100:101], v[100:101], v[108:109]
    v_pk_add_f32 v[102:103], v[102:103], v[110:111]
    s_waitcnt lgkmcnt(1)
    v_pk_add_f32 v[112:113], v[112:113], v[120:121]
    v_pk_add_f32 v[114:115], v[114:115], v[122:123]
    s_waitcnt lgkmcnt(0)
    v_pk_add_f32 v[116:117], v[116:117], v[124:125]
    v_pk_add_f32 v[118:119], v[118:119], v[126:127]
    v_pk_add_f32 v[96:97], v[96:97], v[112:113]
    v_pk_add_f32 v[98:99], v[98:99], v[114:115]
    v_pk_add_f32 v[100:101], v[100:101], v[116:117]
    v_pk_add_f32 v[102:103], v[102:103], v[118:119]
    v_pk_mul_f32 v[96:97], v[96:97], v[184:185]
    v_pk_mul_f32 v[98:99], v[98:99], v[186:187]
    v_pk_mul_f32 v[100:101], v[100:101], v[188:189]
    v_pk_mul_f32 v[102:103], v[102:103], v[190:191]
    v_cvt_pk_bf16_f32 v104, v96, v97
    v_cvt_pk_bf16_f32 v105, v98, v99
    v_cvt_pk_bf16_f32 v106, v100, v101
    v_cvt_pk_bf16_f32 v107, v102, v103
    v_min_u32 v104, -2, v104
    s_add_u32 s68, s85, 16384
    buffer_store_dwordx4 v[104:107], v2, s[28:31], s68 offen sc1
    s_lshl_b32 s76, s48, 2
    s_add_u32 s76, s76, s50
    s_lshl_b32 s76, s76, 7
    s_add_u32 s76, s76, 32768
    buffer_load_dword v6, v36, s[28:31], s76 offen sc1
    ds_read_b128 v[192:195], v33 offset:0
    ds_read_b128 v[196:199], v33 offset:1024
    ds_read_b128 v[200:203], v33 offset:2048
    ds_read_b128 v[204:207], v33 offset:3072
    ds_read_b128 v[208:211], v33 offset:4096
    s_add_u32 m0, s55, 10240
    s_add_u32 s74, s80, 81920
    buffer_load_dwordx4 v2, s[28:31], s74 offen sc1 lds
    s_waitcnt vmcnt(10) lgkmcnt(4)
    v_mfma_f32_16x16x32_bf16 v[16:19], v[192:195], a[0:3], v[16:19]
    ds_read_b128 v[212:215], v33 offset:5120
    s_waitcnt lgkmcnt(4)
    v_mfma_f32_16x16x32_bf16 v[52:55], v[196:199], a[0:3], v[52:55]
    ds_read_b128 v[216:219], v33 offset:6144
    s_waitcnt lgkmcnt(4)
    v_mfma_f32_16x16x32_bf16 v[56:59], v[200:203], a[0:3], v[56:59]
    buffer_load_dwordx4 v2, s[28:31], s74 offen offset:1024 sc1 lds
    ds_read_b128 v[220:223], v33 offset:7168
    s_waitcnt lgkmcnt(4)
    v_mfma_f32_16x16x32_bf16 v[60:63], v[204:207], a[0:3], v[60:63]
    ds_read_b128 v[224:227], v33 offset:8192
    s_waitcnt lgkmcnt(4)
    v_mfma_f32_16x16x32_bf16 v[236:239], v[208:211], a[0:3], v[236:239]
    ds_read_b128 v[228:231], v33 offset:9216
    buffer_load_dwordx4 v2, s[28:31], s74 offen offset:2048 sc1 lds
    s_waitcnt vmcnt(11) lgkmcnt(4)
    v_mfma_f32_16x16x32_bf16 v[16:19], v[212:215], a[4:7], v[16:19]
    ds_read_b128 v[192:195], v33 offset:10240
    s_waitcnt lgkmcnt(4)
    v_mfma_f32_16x16x32_bf16 v[52:55], v[216:219], a[4:7], v[52:55]
    ds_read_b128 v[196:199], v33 offset:11264
    s_waitcnt lgkmcnt(4)
    v_mfma_f32_16x16x32_bf16 v[56:59], v[220:223], a[4:7], v[56:59]
    buffer_load_dwordx4 v2, s[28:31], s74 offen offset:3072 sc1 lds
    ds_read_b128 v[200:203], v33 offset:12288
    s_waitcnt lgkmcnt(4)
    v_mfma_f32_16x16x32_bf16 v[60:63], v[224:227], a[4:7], v[60:63]
    ds_read_b128 v[204:207], v33 offset:13312
    s_waitcnt lgkmcnt(4)
    v_mfma_f32_16x16x32_bf16 v[236:239], v[228:231], a[4:7], v[236:239]
    ds_read_b128 v[208:211], v33 offset:14336
    s_add_u32 m0, s55, 14336
    s_add_u32 s74, s80, 86016
    buffer_load_dwordx4 v2, s[28:31], s74 offen sc1 lds
    s_waitcnt vmcnt(12) lgkmcnt(4)
    v_mfma_f32_16x16x32_bf16 v[16:19], v[192:195], a[8:11], v[16:19]
    ds_read_b128 v[212:215], v33 offset:15360
    s_waitcnt lgkmcnt(4)
    v_mfma_f32_16x16x32_bf16 v[52:55], v[196:199], a[8:11], v[52:55]
    ds_read_b128 v[216:219], v33 offset:16384
    s_waitcnt lgkmcnt(4)
    v_mfma_f32_16x16x32_bf16 v[56:59], v[200:203], a[8:11], v[56:59]
    buffer_load_dwordx4 v2, s[28:31], s74 offen offset:1024 sc1 lds
    ds_read_b128 v[220:223], v33 offset:17408
    s_waitcnt lgkmcnt(4)
    v_mfma_f32_16x16x32_bf16 v[60:63], v[204:207], a[8:11], v[60:63]
    ds_read_b128 v[224:227], v33 offset:18432
    s_waitcnt lgkmcnt(4)
    v_mfma_f32_16x16x32_bf16 v[236:239], v[208:211], a[8:11], v[236:239]
    ds_read_b128 v[228:231], v33 offset:19456
    buffer_load_dwordx4 v2, s[28:31], s74 offen offset:2048 sc1 lds
    s_waitcnt vmcnt(13) lgkmcnt(4)
    v_mfma_f32_16x16x32_bf16 v[16:19], v[212:215], a[12:15], v[16:19]
    ds_read_b128 v[192:195], v33 offset:20480
    s_waitcnt lgkmcnt(4)
    v_mfma_f32_16x16x32_bf16 v[52:55], v[216:219], a[12:15], v[52:55]
    ds_read_b128 v[196:199], v33 offset:21504
    s_waitcnt lgkmcnt(4)
    v_mfma_f32_16x16x32_bf16 v[56:59], v[220:223], a[12:15], v[56:59]
    buffer_load_dwordx4 v2, s[28:31], s74 offen offset:3072 sc1 lds
    ds_read_b128 v[200:203], v33 offset:22528
    s_waitcnt lgkmcnt(4)
    v_mfma_f32_16x16x32_bf16 v[60:63], v[224:227], a[12:15], v[60:63]
    ds_read_b128 v[204:207], v33 offset:23552
    s_waitcnt lgkmcnt(4)
    v_mfma_f32_16x16x32_bf16 v[236:239], v[228:231], a[12:15], v[236:239]
    ds_read_b128 v[208:211], v33 offset:24576
    s_add_u32 m0, s55, 18432
    s_add_u32 s74, s80, 90112
    buffer_load_dwordx4 v2, s[28:31], s74 offen sc1 lds
    s_waitcnt vmcnt(14) lgkmcnt(4)
    v_mfma_f32_16x16x32_bf16 v[16:19], v[192:195], a[16:19], v[16:19]
    ds_read_b128 v[212:215], v33 offset:25600
    s_waitcnt lgkmcnt(4)
    v_mfma_f32_16x16x32_bf16 v[52:55], v[196:199], a[16:19], v[52:55]
    ds_read_b128 v[216:219], v33 offset:26624
    s_waitcnt lgkmcnt(4)
    v_mfma_f32_16x16x32_bf16 v[56:59], v[200:203], a[16:19], v[56:59]
    buffer_load_dwordx4 v2, s[28:31], s74 offen offset:1024 sc1 lds
    ds_read_b128 v[220:223], v33 offset:27648
    s_waitcnt lgkmcnt(4)
    v_mfma_f32_16x16x32_bf16 v[60:63], v[204:207], a[16:19], v[60:63]
    ds_read_b128 v[224:227], v33 offset:28672
    s_waitcnt lgkmcnt(4)
    v_mfma_f32_16x16x32_bf16 v[236:239], v[208:211], a[16:19], v[236:239]
    ds_read_b128 v[228:231], v33 offset:29696
    s_waitcnt vmcnt(14) lgkmcnt(4)
    v_mfma_f32_16x16x32_bf16 v[16:19], v[212:215], a[20:23], v[16:19]
    ds_read_b128 v[192:195], v33 offset:30720
    s_waitcnt lgkmcnt(4)
    v_mfma_f32_16x16x32_bf16 v[52:55], v[216:219], a[20:23], v[52:55]
    ds_read_b128 v[196:199], v33 offset:31744
    s_waitcnt lgkmcnt(4)
    v_mfma_f32_16x16x32_bf16 v[56:59], v[220:223], a[20:23], v[56:59]
    ds_read_b128 v[200:203], v33 offset:32768
    s_waitcnt lgkmcnt(4)
    v_mfma_f32_16x16x32_bf16 v[60:63], v[224:227], a[20:23], v[60:63]
    ds_read_b128 v[204:207], v33 offset:33792
    s_waitcnt lgkmcnt(4)
    v_mfma_f32_16x16x32_bf16 v[236:239], v[228:231], a[20:23], v[236:239]
    ds_read_b128 v[208:211], v33 offset:34816
    s_waitcnt vmcnt(10)
    v_cmp_ne_u32 vcc, s53, v6
    s_nop 0
    s_cbranch_vccnz L_slow4
L_back4:
    s_waitcnt lgkmcnt(4)
    v_mfma_f32_16x16x32_bf16 v[16:19], v[192:195], a[24:27], v[16:19]
    s_add_u32 s73, s67, 8192
    buffer_load_dwordx4 a[64:67], v2, s[28:31], s73 offen offset:0 sc1
    ds_read_b128 v[212:215], v33 offset:35840
    s_waitcnt lgkmcnt(4)
    v_mfma_f32_16x16x32_bf16 v[52:55], v[196:199], a[24:27], v[52:55]
    ds_read_b128 v[216:219], v33 offset:36864
    s_waitcnt lgkmcnt(4)
    v_mfma_f32_16x16x32_bf16 v[56:59], v[200:203], a[24:27], v[56:59]
    buffer_load_dwordx4 a[68:71], v2, s[28:31], s73 offen offset:1024 sc1
    ds_read_b128 v[220:223], v33 offset:37888
    s_waitcnt lgkmcnt(4)
    v_mfma_f32_16x16x32_bf16 v[60:63], v[204:207], a[24:27], v[60:63]
    ds_read_b128 v[224:227], v33 offset:38912
    s_waitcnt lgkmcnt(4)
    v_mfma_f32_16x16x32_bf16 v[236:239], v[208:211], a[24:27], v[236:239]
    buffer_load_dwordx4 a[72:75], v2, s[28:31], s73 offen offset:2048 sc1
    ds_read_b128 v[228:231], v33 offset:39936
    s_waitcnt lgkmcnt(4)
    v_mfma_f32_16x16x32_bf16 v[16:19], v[212:215], a[28:31], v[16:19]
    s_waitcnt lgkmcnt(3)
    v_mfma_f32_16x16x32_bf16 v[52:55], v[216:219], a[28:31], v[52:55]
    s_waitcnt lgkmcnt(2)
    v_mfma_f32_16x16x32_bf16 v[56:59], v[220:223], a[28:31], v[56:59]
    buffer_load_dwordx4 a[76:79], v2, s[28:31], s73 offen offset:3072 sc1
    s_waitcnt lgkmcnt(1)
    v_mfma_f32_16x16x32_bf16 v[60:63], v[224:227], a[28:31], v[60:63]
    s_waitcnt lgkmcnt(0)
    v_mfma_f32_16x16x32_bf16 v[236:239], v[228:231], a[28:31], v[236:239]
    s_add_u32 s74, s67, 12288
    buffer_load_dwordx4 a[80:83], v2, s[28:31], s74 offen offset:0 sc1
    buffer_load_dwordx4 a[84:87], v2, s[28:31], s74 offen offset:1024 sc1
    buffer_load_dwordx4 a[88:91], v2, s[28:31], s74 offen offset:2048 sc1
    buffer_load_dwordx4 a[92:95], v2, s[28:31], s74 offen offset:3072 sc1
    s_waitcnt vmcnt(8)
    s_barrier
    ds_read_b128 a[96:99], v34 offset:10240
    s_add_u32 s73, s67, 16384
    buffer_load_dwordx4 v[128:131], v2, s[28:31], s73 offen offset:0 sc1
    ds_read_b128 a[100:103], v34 offset:11264
    ds_read_b128 a[104:107], v34 offset:12288
    ds_read_b128 a[108:111], v34 offset:13312
    ds_read_b128 a[112:115], v34 offset:14336
    buffer_load_dwordx4 v[132:135], v2, s[28:31], s73 offen offset:1024 sc1
    ds_read_b128 a[116:119], v34 offset:15360
    ds_read_b128 a[120:123], v34 offset:16384
    ds_read_b128 a[124:127], v34 offset:17408
    ds_read_b128 a[128:131], v34 offset:18432
    buffer_load_dwordx4 v[136:139], v2, s[28:31], s73 offen offset:2048 sc1
    ds_read_b128 a[132:135], v34 offset:19456
    ds_read_b128 a[136:139], v34 offset:30720
    ds_read_b128 a[140:143], v34 offset:31744
    ds_read_b128 a[144:147], v34 offset:32768
    buffer_load_dwordx4 v[140:143], v2, s[28:31], s73 offen offset:3072 sc1
    ds_read_b128 a[148:151], v34 offset:33792
    ds_read_b128 a[152:155], v34 offset:34816
    ds_read_b128 a[156:159], v34 offset:35840
    ds_read_b128 a[160:163], v34 offset:36864
    s_add_u32 s74, s67, 20480
    buffer_load_dwordx4 v[144:147], v2, s[28:31], s74 offen offset:0 sc1
    ds_read_b128 a[164:167], v34 offset:37888
    ds_read_b128 a[168:171], v34 offset:38912
    ds_read_b128 a[172:175], v34 offset:39936
    ds_read_b128 a[176:179], v35 offset:10240
    buffer_load_dwordx4 v[148:151], v2, s[28:31], s74 offen offset:1024 sc1
    ds_read_b128 a[180:183], v35 offset:11264
    ds_read_b128 a[184:187], v35 offset:12288
    ds_read_b128 a[188:191], v35 offset:13312
    ds_read_b128 a[192:195], v35 offset:14336
    buffer_load_dwordx4 v[152:155], v2, s[28:31], s74 offen offset:2048 sc1
    ds_read_b128 a[196:199], v35 offset:15360
    ds_read_b128 a[200:203], v35 offset:16384
    ds_read_b128 a[204:207], v35 offset:17408
    ds_read_b128 a[208:211], v35 offset:18432
    buffer_load_dwordx4 v[156:159], v2, s[28:31], s74 offen offset:3072 sc1
    ds_read_b128 a[212:215], v35 offset:19456
    ds_read_b128 a[216:219], v35 offset:30720
    ds_read_b128 a[220:223], v35 offset:31744
    ds_read_b128 a[224:227], v35 offset:32768
    ds_read_b128 a[228:231], v35 offset:33792
    ds_read_b128 a[232:235], v35 offset:34816
    ds_read_b128 a[236:239], v35 offset:35840
    ds_read_b128 a[240:243], v35 offset:36864
    ds_read_b128 a[244:247], v35 offset:37888
    ds_read_b128 a[248:251], v35 offset:38912
    ds_read_b128 a[252:255], v35 offset:39936
    ds_read_b128 v[192:195], v34 offset:0
    ds_read_b128 v[196:199], v34 offset:1024
    ds_read_b128 v[200:203], v34 offset:2048
    ds_read_b128 v[204:207], v34 offset:3072
    ds_read_b128 v[208:211], v34 offset:4096
    s_waitcnt vmcnt(15) lgkmcnt(4)
    v_mfma_f32_16x16x32_bf16 v[16:19], v[192:195], a[64:67], v[16:19]
    ds_read_b128 v[212:215], v34 offset:5120
    s_waitcnt lgkmcnt(4)
    v_mfma_f32_16x16x32_bf16 v[52:55], v[196:199], a[64:67], v[52:55]
    ds_read_b128 v[216:219], v34 offset:6144
    s_waitcnt lgkmcnt(4)
    v_mfma_f32_16x16x32_bf16 v[56:59], v[200:203], a[64:67], v[56:59]
    ds_read_b128 v[220:223], v34 offset:7168
    s_waitcnt lgkmcnt(4)
    v_mfma_f32_16x16x32_bf16 v[60:63], v[204:207], a[64:67], v[60:63]
    ds_read_b128 v[224:227], v34 offset:8192
    s_waitcnt lgkmcnt(4)
    v_mfma_f32_16x16x32_bf16 v[236:239], v[208:211], a[64:67], v[236:239]
    ds_read_b128 v[228:231], v34 offset:9216
    s_waitcnt vmcnt(14) lgkmcnt(4)
    v_mfma_f32_16x16x32_bf16 v[16:19], v[212:215], a[68:71], v[16:19]
    ds_read_b128 v[192:195], v34 offset:20480
    s_waitcnt lgkmcnt(4)
    v_mfma_f32_16x16x32_bf16 v[52:55], v[216:219], a[68:71], v[52:55]
    ds_read_b128 v[196:199], v34 offset:21504
    s_waitcnt lgkmcnt(4)
    v_mfma_f32_16x16x32_bf16 v[56:59], v[220:223], a[68:71], v[56:59]
    ds_read_b128 v[200:203], v34 offset:22528
    s_waitcnt lgkmcnt(4)
    v_mfma_f32_16x16x32_bf16 v[60:63], v[224:227], a[68:71], v[60:63]
    ds_read_b128 v[204:207], v34 offset:23552
    s_waitcnt lgkmcnt(4)
    v_mfma_f32_16x16x32_bf16 v[236:239], v[228:231], a[68:71], v[236:239]
    ds_read_b128 v[208:211], v34 offset:24576
    s_waitcnt vmcnt(13) lgkmcnt(4)
    v_mfma_f32_16x16x32_bf16 v[16:19], v[192:195], a[72:75], v[16:19]
    ds_read_b128 v[212:215], v34 offset:25600
    s_waitcnt lgkmcnt(4)
    v_mfma_f32_16x16x32_bf16 v[52:55], v[196:199], a[72:75], v[52:55]
    ds_read_b128 v[216:219], v34 offset:26624
    s_waitcnt lgkmcnt(4)
    v_mfma_f32_16x16x32_bf16 v[56:59], v[200:203], a[72:75], v[56:59]
    ds_read_b128 v[220:223], v34 offset:27648
    s_waitcnt lgkmcnt(4)
    v_mfma_f32_16x16x32_bf16 v[60:63], v[204:207], a[72:75], v[60:63]
    ds_read_b128 v[224:227], v34 offset:28672
    s_waitcnt lgkmcnt(4)
    v_mfma_f32_16x16x32_bf16 v[236:239], v[208:211], a[72:75], v[236:239]
    ds_read_b128 v[228:231], v34 offset:29696
    s_waitcnt vmcnt(12) lgkmcnt(4)
    v_mfma_f32_16x16x32_bf16 v[16:19], v[212:215], a[76:79], v[16:19]
    ds_read_b128 v[192:195], v35 offset:0
    s_waitcnt lgkmcnt(4)
    v_mfma_f32_16x16x32_bf16 v[52:55], v[216:219], a[76:79], v[52:55]
    ds_read_b128 v[196:199], v35 offset:1024
    s_waitcnt lgkmcnt(4)
    v_mfma_f32_16x16x32_bf16 v[56:59], v[220:223], a[76:79], v[56:59]
    ds_read_b128 v[200:203], v35 offset:2048
    s_waitcnt lgkmcnt(4)
    v_mfma_f32_16x16x32_bf16 v[60:63], v[224:227], a[76:79], v[60:63]
    ds_read_b128 v[204:207], v35 offset:3072
    s_waitcnt lgkmcnt(4)
    v_mfma_f32_16x16x32_bf16 v[236:239], v[228:231], a[76:79], v[236:239]
    ds_read_b128 v[208:211], v35 offset:4096
    s_waitcnt vmcnt(11) lgkmcnt(4)
    v_mfma_f32_16x16x32_bf16 v[16:19], v[192:195], a[80:83], v[16:19]
    ds_read_b128 v[212:215], v35 offset:5120
    s_waitcnt lgkmcnt(4)
    v_mfma_f32_16x16x32_bf16 v[52:55], v[196:199], a[80:83], v[52:55]
    ds_read_b128 v[216:219], v35 offset:6144
    s_waitcnt lgkmcnt(4)
    v_mfma_f32_16x16x32_bf16 v[56:59], v[200:203], a[80:83], v[56:59]
    ds_read_b128 v[220:223], v35 offset:7168
    s_waitcnt lgkmcnt(4)
    v_mfma_f32_16x16x32_bf16 v[60:63], v[204:207], a[80:83], v[60:63]
    ds_read_b128 v[224:227], v35 offset:8192
    s_waitcnt lgkmcnt(4)
    v_mfma_f32_16x16x32_bf16 v[236:239], v[208:211], a[80:83], v[236:239]
    ds_read_b128 v[228:231], v35 offset:9216
    s_waitcnt vmcnt(10) lgkmcnt(4)
    v_mfma_f32_16x16x32_bf16 v[16:19], v[212:215], a[84:87], v[16:19]
    ds_read_b128 v[192:195], v35 offset:20480
    s_waitcnt lgkmcnt(4)
    v_mfma_f32_16x16x32_bf16 v[52:55], v[216:219], a[84:87], v[52:55]
    ds_read_b128 v[196:199], v35 offset:21504
    s_waitcnt lgkmcnt(4)
    v_mfma_f32_16x16x32_bf16 v[56:59], v[220:223], a[84:87], v[56:59]
    ds_read_b128 v[200:203], v35 offset:22528
    s_waitcnt lgkmcnt(4)
    v_mfma_f32_16x16x32_bf16 v[60:63], v[224:227], a[84:87], v[60:63]
    ds_read_b128 v[204:207], v35 offset:23552
    s_waitcnt lgkmcnt(4)
    v_mfma_f32_16x16x32_bf16 v[236:239], v[228:231], a[84:87], v[236:239]
    ds_read_b128 v[208:211], v35 offset:24576
    s_waitcnt vmcnt(9) lgkmcnt(4)
    v_mfma_f32_16x16x32_bf16 v[16:19], v[192:195], a[88:91], v[16:19]
    ds_read_b128 v[212:215], v35 offset:25600
    s_waitcnt lgkmcnt(4)
    v_mfma_f32_16x16x32_bf16 v[52:55], v[196:199], a[88:91], v[52:55]
    ds_read_b128 v[216:219], v35 offset:26624
    s_waitcnt lgkmcnt(4)
    v_mfma_f32_16x16x32_bf16 v[56:59], v[200:203], a[88:91], v[56:59]
    ds_read_b128 v[220:223], v35 offset:27648
    s_waitcnt lgkmcnt(4)
    v_mfma_f32_16x16x32_bf16 v[60:63], v[204:207], a[88:91], v[60:63]
    ds_read_b128 v[224:227], v35 offset:28672
    s_waitcnt lgkmcnt(4)
    v_mfma_f32_16x16x32_bf16 v[236:239], v[208:211], a[88:91], v[236:239]
    ds_read_b128 v[228:231], v35 offset:29696
    s_waitcnt vmcnt(8) lgkmcnt(4)
    v_mfma_f32_16x16x32_bf16 v[16:19], v[212:215], a[92:95], v[16:19]
    s_waitcnt lgkmcnt(3)
    v_mfma_f32_16x16x32_bf16 v[52:55], v[216:219], a[92:95], v[52:55]
    s_waitcnt lgkmcnt(2)
    v_mfma_f32_16x16x32_bf16 v[56:59], v[220:223], a[92:95], v[56:59]
    s_waitcnt lgkmcnt(1)
    v_mfma_f32_16x16x32_bf16 v[60:63], v[224:227], a[92:95], v[60:63]
    s_waitcnt lgkmcnt(0)
    v_mfma_f32_16x16x32_bf16 v[236:239], v[228:231], a[92:95], v[236:239]
    s_waitcnt vmcnt(5)
    v_max3_u32 v64, v128, v132, v136
    s_waitcnt vmcnt(2)
    v_max3_u32 v65, v140, v144, v148
    s_waitcnt vmcnt(0)
    v_max3_u32 v64, v64, v152, v156
    v_max_u32 v64, v64, v65
    v_cmp_eq_u32 vcc, -1, v64
    s_nop 0
    s_cbranch_vccnz L_slow5
L_back5:
    v_mfma_f32_16x16x32_bf16 v[16:19], a[96:99], v[128:131], v[16:19]
    v_mfma_f32_16x16x32_bf16 v[52:55], a[100:103], v[128:131], v[52:55]
    v_mfma_f32_16x16x32_bf16 v[56:59], a[104:107], v[128:131], v[56:59]
    v_mfma_f32_16x16x32_bf16 v[60:63], a[108:111], v[128:131], v[60:63]
    v_mfma_f32_16x16x32_bf16 v[236:239], a[112:115], v[128:131], v[236:239]
    v_mfma_f32_16x16x32_bf16 v[16:19], a[116:119], v[132:135], v[16:19]
    v_mfma_f32_16x16x32_bf16 v[52:55], a[120:123], v[132:135], v[52:55]
    v_mfma_f32_16x16x32_bf16 v[56:59], a[124:127], v[132:135], v[56:59]
    v_mfma_f32_16x16x32_bf16 v[60:63], a[128:131], v[132:135], v[60:63]
    v_mfma_f32_16x16x32_bf16 v[236:239], a[132:135], v[132:135], v[236:239]
    v_mfma_f32_16x16x32_bf16 v[16:19], a[136:139], v[136:139], v[16:19]
    v_mfma_f32_16x16x32_bf16 v[52:55], a[140:143], v[136:139], v[52:55]
    v_mfma_f32_16x16x32_bf16 v[56:59], a[144:147], v[136:139], v[56:59]
    v_mfma_f32_16x16x32_bf16 v[60:63], a[148:151], v[136:139], v[60:63]
    v_mfma_f32_16x16x32_bf16 v[236:239], a[152:155], v[136:139], v[236:239]
    v_mfma_f32_16x16x32_bf16 v[16:19], a[156:159], v[140:143], v[16:19]
    v_mfma_f32_16x16x32_bf16 v[52:55], a[160:163], v[140:143], v[52:55]
    v_mfma_f32_16x16x32_bf16 v[56:59], a[164:167], v[140:143], v[56:59]
    v_mfma_f32_16x16x32_bf16 v[60:63], a[168:171], v[140:143], v[60:63]
    v_mfma_f32_16x16x32_bf16 v[236:239], a[172:175], v[140:143], v[236:239]
    v_mfma_f32_16x16x32_bf16 v[16:19], a[176:179], v[144:147], v[16:19]
    v_mfma_f32_16x16x32_bf16 v[52:55], a[180:183], v[144:147], v[52:55]
    v_mfma_f32_16x16x32_bf16 v[56:59], a[184:187], v[144:147], v[56:59]
    v_mfma_f32_16x16x32_bf16 v[60:63], a[188:191], v[144:147], v[60:63]
    v_mfma_f32_16x16x32_bf16 v[236:239], a[192:195], v[144:147], v[236:239]
    v_mfma_f32_16x16x32_bf16 v[16:19], a[196:199], v[148:151], v[16:19]
    v_mfma_f32_16x16x32_bf16 v[52:55], a[200:203], v[148:151], v[52:55]
    v_mfma_f32_16x16x32_bf16 v[56:59], a[204:207], v[148:151], v[56:59]
    v_mfma_f32_16x16x32_bf16 v[60:63], a[208:211], v[148:151], v[60:63]
    v_mfma_f32_16x16x32_bf16 v[236:239], a[212:215], v[148:151], v[236:239]
    v_mfma_f32_16x16x32_bf16 v[16:19], a[216:219], v[152:155], v[16:19]
    v_mfma_f32_16x16x32_bf16 v[52:55], a[220:223], v[152:155], v[52:55]
    v_mfma_f32_16x16x32_bf16 v[56:59], a[224:227], v[152:155], v[56:59]
    v_mfma_f32_16x16x32_bf16 v[60:63], a[228:231], v[152:155], v[60:63]
    v_mfma_f32_16x16x32_bf16 v[236:239], a[232:235], v[152:155], v[236:239]
    v_mfma_f32_16x16x32_bf16 v[16:19], a[236:239], v[156:159], v[16:19]
    v_mfma_f32_16x16x32_bf16 v[52:55], a[240:243], v[156:159], v[52:55]
    v_mfma_f32_16x16x32_bf16 v[56:59], a[244:247], v[156:159], v[56:59]
    v_mfma_f32_16x16x32_bf16 v[60:63], a[248:251], v[156:159], v[60:63]
    v_mfma_f32_16x16x32_bf16 v[236:239], a[252:255], v[156:159], v[236:239]
    s_mul_i32 s68, s49, 160
    s_add_u32 s68, s68, s56
    s_nop 1
    v_cvt_pk_bf16_f32 v192, v16, v17
    v_cvt_pk_bf16_f32 v193, v18, v19
    v_cvt_pk_bf16_f32 v194, v52, v53
    v_cvt_pk_bf16_f32 v195, v54, v55
    v_cvt_pk_bf16_f32 v196, v56, v57
    v_cvt_pk_bf16_f32 v197, v58, v59
    v_cvt_pk_bf16_f32 v198, v60, v61
    v_cvt_pk_bf16_f32 v199, v62, v63
    v_cvt_pk_bf16_f32 v200, v236, v237
    v_cvt_pk_bf16_f32 v201, v238, v239
    v_permlane16_swap_b32 v192, v194
    v_permlane16_swap_b32 v193, v195
    buffer_store_dwordx4 v[192:195], v37, s[24:27], s68 offen offset:0
    v_permlane16_swap_b32 v196, v198
    v_permlane16_swap_b32 v197, v199
    buffer_store_dwordx4 v[196:199], v37, s[24:27], s68 offen offset:64
    buffer_store_dwordx2 v[200:201], v38, s[24:27], s68 offen offset:128
    s_or_b32 s68, s2, s50
    s_cmp_lg_u32 s68, 0
    s_cbranch_scc1 L_noep
    s_add_u32 s68, s54, 1
    v_mov_b32 v14, s68
    s_mov_b64 exec, 1
    buffer_store_dword v14, v13, s[28:31], 0 offen sc1
    s_mov_b64 exec, -1
L_noep:
    s_endpgm
L_slow0:
    s_mov_b32 s72, 200000
L_sl0:
    s_sleep 4
    buffer_load_dwordx4 v[240:243], v2, s[28:31], s82 offen offset:0 sc1
    buffer_load_dwordx4 v[244:247], v2, s[28:31], s82 offen offset:1024 sc1
    s_waitcnt vmcnt(0)
    v_xor_b32 v42, s53, v241
    s_nop 1
    v_xor_b32 v43, s53, v243
    s_nop 1
    v_or_b32 v42, v42, v43
    s_nop 1
    v_xor_b32 v43, s53, v245
    s_nop 1
    v_or_b32 v42, v42, v43
    s_nop 1
    v_xor_b32 v43, s53, v247
    s_nop 1
    v_or_b32 v42, v42, v43
    s_nop 1
    v_cmp_ne_u32 vcc, 0, v42
    s_nop 1
    s_cbranch_vccz L_back0
    s_sub_u32 s72, s72, 1
    s_cmp_lg_u32 s72, 0
    s_cbranch_scc1 L_sl0
    s_branch L_back0
L_slow1:
    s_mov_b32 s72, 200000
L_sl1:
    s_sleep 4
    buffer_load_dword v50, v24, s[28:31], s75 offen sc1
    s_waitcnt vmcnt(0)
    v_cmp_ne_u32 vcc, s53, v50
    s_nop 1
    s_cbranch_vccz L_back1
    s_sub_u32 s72, s72, 1
    s_cmp_lg_u32 s72, 0
    s_cbranch_scc1 L_sl1
    s_branch L_back1
L_slow2:
    s_mov_b32 s72, 200000
L_sl2:
    s_sleep 4
    buffer_load_dword v4, v24, s[28:31], s76 offen sc1
    s_waitcnt vmcnt(0)
    v_cmp_ne_u32 vcc, s53, v4
    s_nop 1
    s_cbranch_vccz L_back2
    s_sub_u32 s72, s72, 1
    s_cmp_lg_u32 s72, 0
    s_cbranch_scc1 L_sl2
    s_branch L_back2
L_slow3:
    s_mov_b32 s72, 200000
L_sl3:
    s_sleep 4
    buffer_load_dword v5, v36, s[28:31], s75 offen sc1
    s_waitcnt vmcnt(0)
    v_cmp_ne_u32 vcc, s53, v5
    s_nop 1
    s_cbranch_vccz L_back3
    s_sub_u32 s72, s72, 1
    s_cmp_lg_u32 s72, 0
    s_cbranch_scc1 L_sl3
    s_branch L_back3
L_slow4:
    s_mov_b32 s72, 200000
L_sl4:
    s_sleep 4
    buffer_load_dword v6, v36, s[28:31], s76 offen sc1
    s_waitcnt vmcnt(0)
    v_cmp_ne_u32 vcc, s53, v6
    s_nop 1
    s_cbranch_vccz L_back4
    s_sub_u32 s72, s72, 1
    s_cmp_lg_u32 s72, 0
    s_cbranch_scc1 L_sl4
    s_branch L_back4
L_slow5:
    s_mov_b32 s72, 200000
L_sl5:
    s_sleep 4
    buffer_load_dwordx4 v[128:131], v2, s[28:31], s73 offen offset:0 sc1
    buffer_load_dwordx4 v[132:135], v2, s[28:31], s73 offen offset:1024 sc1
    buffer_load_dwordx4 v[136:139], v2, s[28:31], s73 offen offset:2048 sc1
    buffer_load_dwordx4 v[140:143], v2, s[28:31], s73 offen offset:3072 sc1
    buffer_load_dwordx4 v[144:147], v2, s[28:31], s74 offen offset:0 sc1
    buffer_load_dwordx4 v[148:151], v2, s[28:31], s74 offen offset:1024 sc1
    buffer_load_dwordx4 v[152:155], v2, s[28:31], s74 offen offset:2048 sc1
    buffer_load_dwordx4 v[156:159], v2, s[28:31], s74 offen offset:3072 sc1
    s_waitcnt vmcnt(0)
    v_max3_u32 v64, v128, v132, v136
    s_nop 1
    v_max3_u32 v65, v140, v144, v148
    s_nop 1
    v_max3_u32 v64, v64, v152, v156
    s_nop 1
    v_max_u32 v64, v64, v65
    s_nop 1
    v_cmp_eq_u32 vcc, -1, v64
    s_nop 1
    s_cbranch_vccz L_back5
    s_sub_u32 s72, s72, 1
    s_cmp_lg_u32 s72, 0
    s_cbranch_scc1 L_sl5
    s_branch L_back5
L_end:
    s_endpgm
.section .rodata,"a"
.p2align 6
.amdhsa_kernel gated_mix__spectral_fnet__mixer_gmlp__prompt_kernel
  .amdhsa_next_free_vgpr 512
  .amdhsa_next_free_sgpr 102
  .amdhsa_accum_offset 256
  .amdhsa_group_segment_fixed_size 0
  .amdhsa_kernarg_size 112
  .amdhsa_user_sgpr_count 2
  .amdhsa_user_sgpr_kernarg_segment_ptr 1
  .amdhsa_system_sgpr_workgroup_id_x 1
  .amdhsa_float_denorm_mode_32 3
.end_amdhsa_kernel
```
